```python
import torch

def _softmax(x, axis=-1):
    return torch.softmax(x, dim=axis)
def _gelu(x):
    return torch.nn.functional.gelu(x, approximate="tanh")
def _silu(x):
    return torch.nn.functional.silu(x)
def _sigmoid(x):
    return torch.sigmoid(x)
def _layernorm(x, axis=-1, eps=1e-5):
    m = x.mean(dim=axis, keepdim=True)
    v = x.var(dim=axis, keepdim=True, unbiased=False)
    return (x - m) / torch.sqrt(v + eps)
def _scatter_add(tgt, idx, src, axis=0):
    return tgt.clone().index_add_(axis, idx, src)
def _segment_sum(src, seg, n):
    out = torch.zeros((n,) + src.shape[1:], dtype=src.dtype)
    return out.index_add_(0, seg, src)
def _pad(x, pw):
    flat = tuple(v for pair in reversed(pw) for v in pair)
    return torch.nn.functional.pad(x, flat)

kernel_name = 'recurrent_scan__gqa_block_cached__dense_activation_silu__decode'

def setup_inputs():

    _w = (lambda a: (lambda t: t.to(torch.bfloat16) if t.is_floating_point() else t)(torch.as_tensor(a)))
    def _A_setup():
        B, Sq, D = 2, 1, 512
        Hq, Hkv, Sk, Dh = 32, 8, 32768, 128
        assert Hq % Hkv == 0, (Hq, Hkv)
        return {
            "x": _w((lambda *s: torch.randn(*s, dtype=torch.bfloat16) * 0.4)(B, Sq, D)),
            "k_cache": _w((lambda *s: torch.randn(*s, dtype=torch.bfloat16) * 1.6)(B, Hkv, Sk, Dh)),
            "v_cache": _w((lambda *s: torch.randn(*s, dtype=torch.bfloat16) * 1.6)(B, Hkv, Sk, Dh)),
            "wq": _w((lambda *s: torch.randn(*s, dtype=torch.bfloat16) * 1.6)(D, Hq * Dh) * (D ** -0.5)),
            "wo": _w((lambda *s: torch.randn(*s, dtype=torch.bfloat16) * 1.6)(Hq * Dh, D) * ((Hq * Dh) ** -0.5)),
        }
    _A_in = _A_setup()

    def _B_setup():
        B, S, D, F = 2, 1, 512, 1792
        return {
            "x": _w((lambda *s: torch.randn(*s, dtype=torch.bfloat16) * 0.4)(B, S, D)),
            "w1": _w((lambda *s: torch.randn(*s, dtype=torch.bfloat16) * 1.6)(D, F) * (D ** -0.5)),
            "w2": _w((lambda *s: torch.randn(*s, dtype=torch.bfloat16) * 1.6)(F, D) * (F ** -0.5)),
        }
    _B_in = _B_setup()

    return {
        "A_x": _A_in["x"],
        "A_k_cache": _A_in["k_cache"],
        "A_v_cache": _A_in["v_cache"],
        "A_wq": _A_in["wq"],
        "A_wo": _A_in["wo"],
        "B_x": _B_in["x"],
        "B_w1": _B_in["w1"],
        "B_w2": _B_in["w2"],
    }

def reference(A_x, A_k_cache, A_v_cache, A_wq, A_wo, B_x, B_w1, B_w2):
    def _A_ref(x, k_cache, v_cache, wq, wo):
        B, Sq, D = x.shape
        Hq, Dh = 32, 128
        Hkv = k_cache.shape[1]
        rep = Hq // Hkv
        q = (lambda x, *d: x.permute(*d))((x @ wq).reshape(B, Sq, Hq, Dh), 0, 2, 1, 3)
        k = (lambda x, n, axis: torch.repeat_interleave(x, n, dim=axis))(k_cache, rep, axis=1)
        v = (lambda x, n, axis: torch.repeat_interleave(x, n, dim=axis))(v_cache, rep, axis=1)
        scores = torch.einsum("bhqd,bhkd->bhqk", q, k) * (Dh ** -0.5)
        p = _softmax(scores, axis=-1)
        o = torch.einsum("bhqk,bhkd->bhqd", p, v)
        return (lambda x, *d: x.permute(*d))(o, 0, 2, 1, 3).reshape(B, Sq, Hq * Dh) @ wo

    def _B_ref(x, w1, w2):
        h = torch.einsum("bsd,df->bsf", x, w1)
        h = _silu(h)
        out = torch.einsum("bsf,fd->bsd", h, w2)
        return out

    x = A_x
    xn = _layernorm(x, axis=-1)
    s = _A_ref(xn, A_k_cache, A_v_cache, A_wq, A_wo)
    g = _silu(_B_ref(xn, B_w1, B_w2))
    return x + s * g
```

```asm
; @launch grid=(256,1,1) block=(512,1,1) lds=83968
.amdgcn_target "amdgcn-amd-amdhsa--gfx950"
.text
.globl recurrent_scan__gqa_block_cached__dense_activation_silu__decode_kernel
.p2align 8
.type recurrent_scan__gqa_block_cached__dense_activation_silu__decode_kernel,@function
recurrent_scan__gqa_block_cached__dense_activation_silu__decode_kernel:
  s_cmp_ge_u32 s2, 256
  s_cbranch_scc1 L_end
  s_load_dwordx8 s[8:15], s[0:1], 0
  v_lshrrev_b32 v28, 6, v0
  v_and_b32 v1, 63, v0
  v_readfirstlane_b32 s31, v28
  s_lshr_b32 s40, s2, 3
  s_and_b32 s41, s2, 7
  s_lshr_b32 s46, s2, 7
  s_and_b32 s40, s40, 15
  s_lshl_b32 s46, s46, 3
  v_lshlrev_b32 v3, 4, v1
  s_add_u32 s41, s41, s46
  v_lshrrev_b32 v28, 4, v1
  v_bfe_u32 v29, v1, 2, 2
  v_and_b32 v30, 3, v1
  s_cmp_lt_u32 s31, 4
  s_cbranch_scc1 L_stream
  s_cmp_lg_u32 s31, 7
  s_cbranch_scc1 L_nocpf
  s_cmp_ge_u32 s2, 16
  s_cbranch_scc1 L_nocpf
  s_getpc_b64 s[50:51]
L_pc:
  s_sub_u32 s50, s50, L_pc-recurrent_scan__gqa_block_cached__dense_activation_silu__decode_kernel
  s_subb_u32 s51, s51, 0
  v_lshlrev_b32 v26, 7, v1
  s_mov_b32 s46, L_code_end-recurrent_scan__gqa_block_cached__dense_activation_silu__decode_kernel-4
  v_min_u32 v27, s46, v26
  global_load_dword v96, v27, s[50:51]
  v_add_u32 v26, 8192, v26
  v_min_u32 v27, s46, v26
  global_load_dword v97, v27, s[50:51]
  v_add_u32 v26, 8192, v26
  v_min_u32 v27, s46, v26
  global_load_dword v98, v27, s[50:51]
L_nocpf:
  s_and_b32 s50, s2, 1
  s_lshl_b32 s50, s50, 9
  v_lshlrev_b32 v23, 3, v1
  s_bitcmp1_b32 s2, 2
  v_add_u32 v23, s50, v23
  s_cbranch_scc1 L_helper
  s_cmp_gt_u32 s31, 5
  s_cbranch_scc1 L_helper
  s_waitcnt lgkmcnt(0)
  global_load_dwordx4 v[224:227], v3, s[8:9]
  global_load_dwordx4 v[228:231], v3, s[8:9] offset:1024
  global_load_dwordx2 v[232:233], v23, s[8:9]
  global_load_dwordx2 v[234:235], v23, s[8:9] offset:1024
  s_branch L_helper
L_stream:
  v_lshlrev_b32 v31, 6, v28
  s_lshl_b32 s60, s41, 2
  v_lshl_add_u32 v31, v29, 8, v31
  s_add_u32 s60, s60, s31
  v_lshl_add_u32 v2, v30, 4, v31
  s_lshl_b32 s60, s60, 13
  s_lshl_b32 s51, s40, 23
  s_mov_b32 s34, 0x800000
  s_mov_b32 s35, 0x20000
  s_add_u32 s61, s60, 4096
  s_bitcmp1_b32 s2, 2
  s_cbranch_scc0 L_s_prod
  s_waitcnt lgkmcnt(0)
  s_add_u32 s32, s10, s51
  s_addc_u32 s33, s11, 0
  s_and_b32 s33, s33, 0xffff
  buffer_load_dwordx4 v[96:99], v2, s[32:35], s60 offen offset:0 nt
  buffer_load_dwordx4 v[100:103], v2, s[32:35], s60 offen offset:1024 nt
  buffer_load_dwordx4 v[104:107], v2, s[32:35], s60 offen offset:2048 nt
  buffer_load_dwordx4 v[108:111], v2, s[32:35], s60 offen offset:3072 nt
  buffer_load_dwordx4 v[112:115], v2, s[32:35], s61 offen offset:0 nt
  buffer_load_dwordx4 v[116:119], v2, s[32:35], s61 offen offset:1024 nt
  buffer_load_dwordx4 v[120:123], v2, s[32:35], s61 offen offset:2048 nt
  buffer_load_dwordx4 v[124:127], v2, s[32:35], s61 offen offset:3072 nt
  s_barrier
  s_branch L_s_v0
L_s_prod:
  s_lshr_b32 s3, s2, 3
  s_lshl_b32 s3, s3, 2
  s_and_b32 s46, s2, 3
  s_add_u32 s3, s3, s46
  v_lshrrev_b32 v20, 3, v1
  v_and_b32 v21, 7, v1
  v_lshlrev_b32 v21, 4, v21
  v_lshl_add_u32 v22, v20, 13, v21
  s_and_b32 s46, s3, 1
  s_lshl_b32 s46, s46, 21
  s_lshl_b32 s47, s31, 19
  s_add_u32 s46, s46, s47
  s_lshr_b32 s47, s3, 1
  s_lshl_b32 s47, s47, 7
  s_add_u32 s46, s46, s47
  s_lshl_b32 s47, s31, 13
  s_add_u32 s47, s47, 5120
  s_mov_b32 m0, s47
  s_waitcnt lgkmcnt(0)
  s_add_u32 s48, s14, s46
  s_addc_u32 s49, s15, 0
  global_load_lds_dwordx4 v22, s[48:49] offset:0 nt
  v_add_u32 v22, 64512, v22
  global_load_lds_dwordx4 v22, s[48:49] offset:1024 nt
  v_add_u32 v22, 64512, v22
  global_load_lds_dwordx4 v22, s[48:49] offset:2048 nt
  v_add_u32 v22, 64512, v22
  global_load_lds_dwordx4 v22, s[48:49] offset:3072 nt
  v_add_u32 v22, 64512, v22
  s_add_u32 m0, s47, 4096
  v_add_u32 v22, 4096, v22
  global_load_lds_dwordx4 v22, s[48:49] offset:0 nt
  v_add_u32 v22, 64512, v22
  global_load_lds_dwordx4 v22, s[48:49] offset:1024 nt
  v_add_u32 v22, 64512, v22
  global_load_lds_dwordx4 v22, s[48:49] offset:2048 nt
  v_add_u32 v22, 64512, v22
  global_load_lds_dwordx4 v22, s[48:49] offset:3072 nt
  s_add_u32 s32, s10, s51
  s_addc_u32 s33, s11, 0
  s_and_b32 s33, s33, 0xffff
  s_barrier
  s_waitcnt vmcnt(7)
  buffer_load_dwordx4 v[96:99], v2, s[32:35], s60 offen offset:0 nt
  s_waitcnt vmcnt(7)
  buffer_load_dwordx4 v[100:103], v2, s[32:35], s60 offen offset:1024 nt
  s_waitcnt vmcnt(7)
  buffer_load_dwordx4 v[104:107], v2, s[32:35], s60 offen offset:2048 nt
  s_waitcnt vmcnt(7)
  buffer_load_dwordx4 v[108:111], v2, s[32:35], s60 offen offset:3072 nt
  s_waitcnt vmcnt(7)
  buffer_load_dwordx4 v[112:115], v2, s[32:35], s61 offen offset:0 nt
  s_waitcnt vmcnt(7)
  buffer_load_dwordx4 v[116:119], v2, s[32:35], s61 offen offset:1024 nt
  s_waitcnt vmcnt(7)
  buffer_load_dwordx4 v[120:123], v2, s[32:35], s61 offen offset:2048 nt
  s_waitcnt vmcnt(7)
  s_lshl_b32 s46, s31, 2
  s_add_u32 s46, s46, 4368
  v_mov_b32 v24, s46
  v_mov_b32 v25, 1
  ds_write_b32 v24, v25
  buffer_load_dwordx4 v[124:127], v2, s[32:35], s61 offen offset:3072 nt
L_s_v0:
  s_add_u32 s36, s12, s51
  s_addc_u32 s37, s13, 0
  s_and_b32 s37, s37, 0xffff
  s_mov_b32 s38, 0x800000
  s_mov_b32 s39, 0x20000
  s_add_u32 s62, s60, 524288
  s_load_dwordx8 s[16:23], s[0:1], 32
  s_load_dwordx4 s[24:27], s[0:1], 64
  s_load_dwordx2 s[28:29], s[0:1], 80
  s_add_u32 s61, s60, 4096
  s_waitcnt vmcnt(7)
  buffer_load_dwordx4 v[128:131], v3, s[36:39], s60 offen offset:0 nt
  s_waitcnt vmcnt(7)
  buffer_load_dwordx4 v[132:135], v3, s[36:39], s60 offen offset:1024 nt
  s_waitcnt vmcnt(7)
  buffer_load_dwordx4 v[136:139], v3, s[36:39], s60 offen offset:2048 nt
  s_waitcnt vmcnt(7)
  buffer_load_dwordx4 v[140:143], v3, s[36:39], s60 offen offset:3072 nt
  s_waitcnt vmcnt(7)
  buffer_load_dwordx4 v[144:147], v3, s[36:39], s61 offen offset:0 nt
  s_waitcnt vmcnt(7)
  buffer_load_dwordx4 v[148:151], v3, s[36:39], s61 offen offset:1024 nt
  s_waitcnt vmcnt(7)
  buffer_load_dwordx4 v[152:155], v3, s[36:39], s61 offen offset:2048 nt
  s_waitcnt vmcnt(7)
  buffer_load_dwordx4 v[156:159], v3, s[36:39], s61 offen offset:3072 nt
  s_add_u32 s63, s62, 4096
  s_waitcnt vmcnt(7)
  buffer_load_dwordx4 v[160:163], v2, s[32:35], s62 offen offset:0 nt
  s_waitcnt vmcnt(7)
  buffer_load_dwordx4 v[164:167], v2, s[32:35], s62 offen offset:1024 nt
  s_waitcnt vmcnt(7)
  buffer_load_dwordx4 v[168:171], v2, s[32:35], s62 offen offset:2048 nt
  s_waitcnt vmcnt(7)
  buffer_load_dwordx4 v[172:175], v2, s[32:35], s62 offen offset:3072 nt
  s_waitcnt vmcnt(7)
  buffer_load_dwordx4 v[176:179], v2, s[32:35], s63 offen offset:0 nt
  s_waitcnt vmcnt(7)
  buffer_load_dwordx4 v[180:183], v2, s[32:35], s63 offen offset:1024 nt
  s_waitcnt vmcnt(7)
  buffer_load_dwordx4 v[184:187], v2, s[32:35], s63 offen offset:2048 nt
  s_waitcnt vmcnt(7)
  buffer_load_dwordx4 v[188:191], v2, s[32:35], s63 offen offset:3072 nt
  s_add_u32 s63, s62, 4096
  s_waitcnt vmcnt(7)
  buffer_load_dwordx4 v[192:195], v3, s[36:39], s62 offen offset:0 nt
  s_waitcnt vmcnt(7)
  buffer_load_dwordx4 v[196:199], v3, s[36:39], s62 offen offset:1024 nt
  s_waitcnt vmcnt(7)
  buffer_load_dwordx4 v[200:203], v3, s[36:39], s62 offen offset:2048 nt
  s_waitcnt vmcnt(7)
  buffer_load_dwordx4 v[204:207], v3, s[36:39], s62 offen offset:3072 nt
  s_waitcnt vmcnt(7)
  buffer_load_dwordx4 v[208:211], v3, s[36:39], s63 offen offset:0 nt
  s_waitcnt vmcnt(7)
  buffer_load_dwordx4 v[212:215], v3, s[36:39], s63 offen offset:1024 nt
  s_waitcnt vmcnt(7)
  buffer_load_dwordx4 v[216:219], v3, s[36:39], s63 offen offset:2048 nt
  s_waitcnt vmcnt(7)
  buffer_load_dwordx4 v[220:223], v3, s[36:39], s63 offen offset:3072 nt
  s_waitcnt lgkmcnt(0)
  s_load_dword s30, s[28:29], 0
  s_mov_b32 s52, 0x3db504f3
  s_mov_b32 s53, 0x3fb8aa3b
  s_mov_b32 s56, 0xffff0000
  s_mov_b32 s54, 0x05040100
  s_mov_b32 s55, 0x07060302
  s_mov_b32 s70, 0
  s_mov_b32 s67, 0
  s_and_b32 s46, s2, 7
  s_lshl_b32 s46, s46, 2
  s_bfe_u32 s47, s2, 0x20003
  s_add_u32 s57, s46, s47
  s_lshr_b32 s58, s2, 5
  v_mov_b32 v32, 0
  v_mov_b32 v33, 0
  v_mov_b32 v34, 0
  v_mov_b32 v35, 0
  v_mov_b32 v36, 0
  v_mov_b32 v37, 0
  v_mov_b32 v38, 0
  v_mov_b32 v39, 0
  v_mov_b32 v40, 0
  v_mov_b32 v41, 0
  v_mov_b32 v42, 0
  v_mov_b32 v43, 0
  v_mov_b32 v44, 0
  v_mov_b32 v45, 0
  v_mov_b32 v46, 0
  v_mov_b32 v47, 0
  v_mov_b32 v48, 0
  v_mov_b32 v49, 0
  v_mov_b32 v50, 0
  v_mov_b32 v51, 0
  v_mov_b32 v52, 0
  v_mov_b32 v53, 0
  v_mov_b32 v54, 0
  v_mov_b32 v55, 0
  v_mov_b32 v56, 0
  v_mov_b32 v57, 0
  v_mov_b32 v58, 0
  v_mov_b32 v59, 0
  v_mov_b32 v60, 0
  v_mov_b32 v61, 0
  v_mov_b32 v62, 0
  v_mov_b32 v63, 0
  v_mov_b32 v8, 0xff7fffff
  v_mov_b32 v9, 0
  s_lshl_b32 s46, s40, 8
  s_add_u32 s46, s46, 4096
  s_add_u32 s68, s28, s46
  s_addc_u32 s69, s29, 0
  v_mov_b32 v225, 0
  v_mov_b32 v226, 1
  s_mov_b32 s71, 0
  s_mov_b32 s65, 0
  s_mov_b32 s7, 3
  s_mov_b32 s4, 0
  s_mov_b32 s5, 0
  s_waitcnt lgkmcnt(0)
  s_mul_i32 s30, s30, 0x9e3779b1
  s_add_u32 s30, s30, 0x85ebca6b
  v_mov_b32 v24, 4352
L_qf_spin:
  ds_read_b32 v25, v24
  s_waitcnt lgkmcnt(0)
  v_cmp_ne_u32 vcc, 1, v25
  s_cbranch_vccz L_qf_ok
  s_add_u32 s70, s70, 1
  s_cmp_gt_u32 s70, 2000000
  s_cbranch_scc1 L_end
  s_sleep 1
  s_branch L_qf_spin
L_qf_ok:
  ds_read_b128 v[4:7], v3 offset:3072
  s_waitcnt lgkmcnt(0)
L_bodyA:
  s_cmp_eq_u32 s71, 0
  s_cbranch_scc1 L_A_first1
  s_waitcnt vmcnt(8)
  s_cmp_eq_u32 s67, 1
  s_cbranch_scc1 L_A_done
  v_readfirstlane_b32 s46, v224
  s_nop 0
  s_add_u32 s46, s46, 192
  s_cmp_ge_u32 s46, 1024
  s_cbranch_scc1 L_A_done
  s_lshl_b32 s62, s46, 13
  s_add_u32 s63, s62, 4096
  buffer_load_dwordx4 v[160:163], v2, s[32:35], s62 offen offset:0 nt
  buffer_load_dwordx4 v[164:167], v2, s[32:35], s62 offen offset:1024 nt
  buffer_load_dwordx4 v[168:171], v2, s[32:35], s62 offen offset:2048 nt
  buffer_load_dwordx4 v[172:175], v2, s[32:35], s62 offen offset:3072 nt
  buffer_load_dwordx4 v[176:179], v2, s[32:35], s63 offen offset:0 nt
  buffer_load_dwordx4 v[180:183], v2, s[32:35], s63 offen offset:1024 nt
  buffer_load_dwordx4 v[184:187], v2, s[32:35], s63 offen offset:2048 nt
  buffer_load_dwordx4 v[188:191], v2, s[32:35], s63 offen offset:3072 nt
  s_branch L_A_qk
L_A_done:
  s_mov_b32 s65, 1
  s_branch L_A_qk
L_A_first1:
  s_waitcnt vmcnt(24)
L_A_qk:
  v_mfma_f32_16x16x32_bf16 v[64:67], v[96:99], v[4:7], 0
  v_mfma_f32_16x16x32_bf16 v[68:71], v[100:103], v[4:7], 0
  v_mfma_f32_16x16x32_bf16 v[72:75], v[104:107], v[4:7], 0
  v_mfma_f32_16x16x32_bf16 v[76:79], v[108:111], v[4:7], 0
  v_mfma_f32_16x16x32_bf16 v[80:83], v[112:115], v[4:7], 0
  v_mfma_f32_16x16x32_bf16 v[84:87], v[116:119], v[4:7], 0
  v_mfma_f32_16x16x32_bf16 v[88:91], v[120:123], v[4:7], 0
  v_mfma_f32_16x16x32_bf16 v[92:95], v[124:127], v[4:7], 0
  s_nop 0
  v_add_f32_dpp v16, v65, v64 row_shl:4 row_mask:0xf bank_mask:0xf bound_ctrl:0
  v_add_f32_dpp v17, v69, v68 row_shl:4 row_mask:0xf bank_mask:0xf bound_ctrl:0
  v_add_f32_dpp v18, v73, v72 row_shl:4 row_mask:0xf bank_mask:0xf bound_ctrl:0
  v_add_f32_dpp v19, v77, v76 row_shl:4 row_mask:0xf bank_mask:0xf bound_ctrl:0
  v_add_f32_dpp v20, v81, v80 row_shl:4 row_mask:0xf bank_mask:0xf bound_ctrl:0
  v_add_f32_dpp v21, v85, v84 row_shl:4 row_mask:0xf bank_mask:0xf bound_ctrl:0
  v_add_f32_dpp v22, v89, v88 row_shl:4 row_mask:0xf bank_mask:0xf bound_ctrl:0
  v_add_f32_dpp v23, v93, v92 row_shl:4 row_mask:0xf bank_mask:0xf bound_ctrl:0
  v_add_f32_dpp v16, v66, v16 row_shl:8 row_mask:0xf bank_mask:0xf bound_ctrl:0
  v_add_f32_dpp v17, v70, v17 row_shl:8 row_mask:0xf bank_mask:0xf bound_ctrl:0
  v_add_f32_dpp v18, v74, v18 row_shl:8 row_mask:0xf bank_mask:0xf bound_ctrl:0
  v_add_f32_dpp v19, v78, v19 row_shl:8 row_mask:0xf bank_mask:0xf bound_ctrl:0
  v_add_f32_dpp v20, v82, v20 row_shl:8 row_mask:0xf bank_mask:0xf bound_ctrl:0
  v_add_f32_dpp v21, v86, v21 row_shl:8 row_mask:0xf bank_mask:0xf bound_ctrl:0
  v_add_f32_dpp v22, v90, v22 row_shl:8 row_mask:0xf bank_mask:0xf bound_ctrl:0
  v_add_f32_dpp v23, v94, v23 row_shl:8 row_mask:0xf bank_mask:0xf bound_ctrl:0
  v_add_f32_dpp v16, v67, v16 row_shl:12 row_mask:0xf bank_mask:0xf bound_ctrl:0
  v_add_f32_dpp v17, v71, v17 row_shl:12 row_mask:0xf bank_mask:0xf bound_ctrl:0
  v_add_f32_dpp v18, v75, v18 row_shl:12 row_mask:0xf bank_mask:0xf bound_ctrl:0
  v_add_f32_dpp v19, v79, v19 row_shl:12 row_mask:0xf bank_mask:0xf bound_ctrl:0
  v_add_f32_dpp v20, v83, v20 row_shl:12 row_mask:0xf bank_mask:0xf bound_ctrl:0
  v_add_f32_dpp v21, v87, v21 row_shl:12 row_mask:0xf bank_mask:0xf bound_ctrl:0
  v_add_f32_dpp v22, v91, v22 row_shl:12 row_mask:0xf bank_mask:0xf bound_ctrl:0
  v_add_f32_dpp v23, v95, v23 row_shl:12 row_mask:0xf bank_mask:0xf bound_ctrl:0
  v_cvt_pk_bf16_f32 v28, v16, v17
  v_cvt_pk_bf16_f32 v29, v18, v19
  v_cvt_pk_bf16_f32 v30, v20, v21
  v_cvt_pk_bf16_f32 v31, v22, v23
  v_lshlrev_b32 v16, 16, v28
  v_and_b32 v17, s56, v28
  v_lshlrev_b32 v18, 16, v29
  v_and_b32 v19, s56, v29
  v_lshlrev_b32 v20, 16, v30
  v_and_b32 v21, s56, v30
  v_lshlrev_b32 v22, 16, v31
  v_and_b32 v23, s56, v31
  v_mul_f32 v16, s52, v16
  v_mul_f32 v17, s52, v17
  v_mul_f32 v18, s52, v18
  v_mul_f32 v19, s52, v19
  v_mul_f32 v20, s52, v20
  v_mul_f32 v21, s52, v21
  v_mul_f32 v22, s52, v22
  v_mul_f32 v23, s52, v23
  v_cvt_pk_bf16_f32 v28, v16, v17
  v_cvt_pk_bf16_f32 v29, v18, v19
  v_cvt_pk_bf16_f32 v30, v20, v21
  v_cvt_pk_bf16_f32 v31, v22, v23
  v_lshlrev_b32 v16, 16, v28
  v_and_b32 v17, s56, v28
  v_lshlrev_b32 v18, 16, v29
  v_and_b32 v19, s56, v29
  v_lshlrev_b32 v20, 16, v30
  v_and_b32 v21, s56, v30
  v_lshlrev_b32 v22, 16, v31
  v_and_b32 v23, s56, v31
  v_max3_f32 v10, v16, v17, v8
  v_max3_f32 v13, v18, v19, v20
  v_max3_f32 v14, v21, v22, v23
  v_max3_f32 v10, v10, v13, v14
  v_sub_f32 v11, v8, v10
  v_mul_f32 v12, s53, v10
  v_mul_f32 v11, s53, v11
  v_mov_b32 v8, v10
  v_exp_f32 v11, v11
  v_fma_f32 v16, v16, s53, -v12
  v_fma_f32 v17, v17, s53, -v12
  v_fma_f32 v18, v18, s53, -v12
  v_fma_f32 v19, v19, s53, -v12
  v_fma_f32 v20, v20, s53, -v12
  v_fma_f32 v21, v21, s53, -v12
  v_fma_f32 v22, v22, s53, -v12
  v_fma_f32 v23, v23, s53, -v12
  v_exp_f32 v16, v16
  v_exp_f32 v17, v17
  v_exp_f32 v18, v18
  v_exp_f32 v19, v19
  v_exp_f32 v20, v20
  v_exp_f32 v21, v21
  v_exp_f32 v22, v22
  v_exp_f32 v23, v23
  s_cmp_lg_u32 s71, 0
  s_cbranch_scc1 L_A_nok2
  s_add_u32 s60, s60, 1048576
  s_add_u32 s61, s60, 4096
  buffer_load_dwordx4 v[96:99], v2, s[32:35], s60 offen offset:0 nt
  buffer_load_dwordx4 v[100:103], v2, s[32:35], s60 offen offset:1024 nt
  buffer_load_dwordx4 v[104:107], v2, s[32:35], s60 offen offset:2048 nt
  buffer_load_dwordx4 v[108:111], v2, s[32:35], s60 offen offset:3072 nt
  buffer_load_dwordx4 v[112:115], v2, s[32:35], s61 offen offset:0 nt
  buffer_load_dwordx4 v[116:119], v2, s[32:35], s61 offen offset:1024 nt
  buffer_load_dwordx4 v[120:123], v2, s[32:35], s61 offen offset:2048 nt
  buffer_load_dwordx4 v[124:127], v2, s[32:35], s61 offen offset:3072 nt
L_A_nok2:
  v_mul_f32_dpp v32, v11, v32 row_newbcast:0 row_mask:0xf bank_mask:0xf
  v_mul_f32_dpp v33, v11, v33 row_newbcast:1 row_mask:0xf bank_mask:0xf
  v_mul_f32_dpp v34, v11, v34 row_newbcast:2 row_mask:0xf bank_mask:0xf
  v_mul_f32_dpp v35, v11, v35 row_newbcast:3 row_mask:0xf bank_mask:0xf
  v_mul_f32_dpp v36, v11, v36 row_newbcast:0 row_mask:0xf bank_mask:0xf
  v_mul_f32_dpp v37, v11, v37 row_newbcast:1 row_mask:0xf bank_mask:0xf
  v_mul_f32_dpp v38, v11, v38 row_newbcast:2 row_mask:0xf bank_mask:0xf
  v_mul_f32_dpp v39, v11, v39 row_newbcast:3 row_mask:0xf bank_mask:0xf
  v_mul_f32_dpp v40, v11, v40 row_newbcast:0 row_mask:0xf bank_mask:0xf
  v_mul_f32_dpp v41, v11, v41 row_newbcast:1 row_mask:0xf bank_mask:0xf
  v_mul_f32_dpp v42, v11, v42 row_newbcast:2 row_mask:0xf bank_mask:0xf
  v_mul_f32_dpp v43, v11, v43 row_newbcast:3 row_mask:0xf bank_mask:0xf
  v_mul_f32_dpp v44, v11, v44 row_newbcast:0 row_mask:0xf bank_mask:0xf
  v_mul_f32_dpp v45, v11, v45 row_newbcast:1 row_mask:0xf bank_mask:0xf
  v_mul_f32_dpp v46, v11, v46 row_newbcast:2 row_mask:0xf bank_mask:0xf
  v_mul_f32_dpp v47, v11, v47 row_newbcast:3 row_mask:0xf bank_mask:0xf
  v_mul_f32_dpp v48, v11, v48 row_newbcast:0 row_mask:0xf bank_mask:0xf
  v_mul_f32_dpp v49, v11, v49 row_newbcast:1 row_mask:0xf bank_mask:0xf
  v_mul_f32_dpp v50, v11, v50 row_newbcast:2 row_mask:0xf bank_mask:0xf
  v_mul_f32_dpp v51, v11, v51 row_newbcast:3 row_mask:0xf bank_mask:0xf
  v_mul_f32_dpp v52, v11, v52 row_newbcast:0 row_mask:0xf bank_mask:0xf
  v_mul_f32_dpp v53, v11, v53 row_newbcast:1 row_mask:0xf bank_mask:0xf
  v_mul_f32_dpp v54, v11, v54 row_newbcast:2 row_mask:0xf bank_mask:0xf
  v_mul_f32_dpp v55, v11, v55 row_newbcast:3 row_mask:0xf bank_mask:0xf
  v_mul_f32_dpp v56, v11, v56 row_newbcast:0 row_mask:0xf bank_mask:0xf
  v_mul_f32_dpp v57, v11, v57 row_newbcast:1 row_mask:0xf bank_mask:0xf
  v_mul_f32_dpp v58, v11, v58 row_newbcast:2 row_mask:0xf bank_mask:0xf
  v_mul_f32_dpp v59, v11, v59 row_newbcast:3 row_mask:0xf bank_mask:0xf
  v_mul_f32_dpp v60, v11, v60 row_newbcast:0 row_mask:0xf bank_mask:0xf
  v_mul_f32_dpp v61, v11, v61 row_newbcast:1 row_mask:0xf bank_mask:0xf
  v_mul_f32_dpp v62, v11, v62 row_newbcast:2 row_mask:0xf bank_mask:0xf
  v_mul_f32_dpp v63, v11, v63 row_newbcast:3 row_mask:0xf bank_mask:0xf
  v_cvt_pk_bf16_f32 v24, v16, v17
  v_cvt_pk_bf16_f32 v25, v18, v19
  v_cvt_pk_bf16_f32 v26, v20, v21
  v_cvt_pk_bf16_f32 v27, v22, v23
  v_add_f32 v13, v16, v17
  v_add_f32 v14, v18, v19
  v_add_f32 v15, v20, v21
  v_add_f32 v10, v22, v23
  v_add_f32 v13, v13, v14
  v_add_f32 v15, v15, v10
  v_add_f32 v13, v13, v15
  v_fma_f32 v9, v9, v11, v13
  s_cmp_eq_u32 s65, 1
  s_cbranch_scc1 L_A_w0
  s_waitcnt vmcnt(8)
  s_branch L_A_pv
L_A_w0:
  s_waitcnt vmcnt(0)
L_A_pv:
  v_perm_b32 v64, v132, v128, s54
  v_perm_b32 v68, v132, v128, s55
  v_perm_b32 v65, v140, v136, s54
  v_perm_b32 v69, v140, v136, s55
  v_perm_b32 v66, v148, v144, s54
  v_perm_b32 v70, v148, v144, s55
  v_perm_b32 v67, v156, v152, s54
  v_perm_b32 v71, v156, v152, s55
  v_perm_b32 v72, v133, v129, s54
  v_perm_b32 v76, v133, v129, s55
  v_perm_b32 v73, v141, v137, s54
  v_perm_b32 v77, v141, v137, s55
  v_perm_b32 v74, v149, v145, s54
  v_perm_b32 v78, v149, v145, s55
  v_perm_b32 v75, v157, v153, s54
  v_perm_b32 v79, v157, v153, s55
  v_mfma_f32_4x4x4_16b_bf16 v[32:35], v[24:25], v[64:65], v[32:35] cbsz:2 abid:0
  v_mfma_f32_4x4x4_16b_bf16 v[36:39], v[24:25], v[68:69], v[36:39] cbsz:2 abid:0
  v_mfma_f32_4x4x4_16b_bf16 v[40:43], v[24:25], v[72:73], v[40:43] cbsz:2 abid:0
  v_mfma_f32_4x4x4_16b_bf16 v[44:47], v[24:25], v[76:77], v[44:47] cbsz:2 abid:0
  v_mfma_f32_4x4x4_16b_bf16 v[32:35], v[26:27], v[66:67], v[32:35] cbsz:2 abid:0
  v_mfma_f32_4x4x4_16b_bf16 v[36:39], v[26:27], v[70:71], v[36:39] cbsz:2 abid:0
  v_mfma_f32_4x4x4_16b_bf16 v[40:43], v[26:27], v[74:75], v[40:43] cbsz:2 abid:0
  v_mfma_f32_4x4x4_16b_bf16 v[44:47], v[26:27], v[78:79], v[44:47] cbsz:2 abid:0
  v_perm_b32 v80, v134, v130, s54
  v_perm_b32 v84, v134, v130, s55
  v_perm_b32 v81, v142, v138, s54
  v_perm_b32 v85, v142, v138, s55
  v_perm_b32 v82, v150, v146, s54
  v_perm_b32 v86, v150, v146, s55
  v_perm_b32 v83, v158, v154, s54
  v_perm_b32 v87, v158, v154, s55
  v_perm_b32 v88, v135, v131, s54
  v_perm_b32 v92, v135, v131, s55
  v_perm_b32 v89, v143, v139, s54
  v_perm_b32 v93, v143, v139, s55
  v_perm_b32 v90, v151, v147, s54
  v_perm_b32 v94, v151, v147, s55
  v_perm_b32 v91, v159, v155, s54
  v_perm_b32 v95, v159, v155, s55
  v_mfma_f32_4x4x4_16b_bf16 v[48:51], v[24:25], v[80:81], v[48:51] cbsz:2 abid:0
  v_mfma_f32_4x4x4_16b_bf16 v[52:55], v[24:25], v[84:85], v[52:55] cbsz:2 abid:0
  v_mfma_f32_4x4x4_16b_bf16 v[56:59], v[24:25], v[88:89], v[56:59] cbsz:2 abid:0
  v_mfma_f32_4x4x4_16b_bf16 v[60:63], v[24:25], v[92:93], v[60:63] cbsz:2 abid:0
  v_mfma_f32_4x4x4_16b_bf16 v[48:51], v[26:27], v[82:83], v[48:51] cbsz:2 abid:0
  v_mfma_f32_4x4x4_16b_bf16 v[52:55], v[26:27], v[86:87], v[52:55] cbsz:2 abid:0
  v_mfma_f32_4x4x4_16b_bf16 v[56:59], v[26:27], v[90:91], v[56:59] cbsz:2 abid:0
  v_mfma_f32_4x4x4_16b_bf16 v[60:63], v[26:27], v[94:95], v[60:63] cbsz:2 abid:0
  s_cmp_eq_u32 s65, 1
  s_cbranch_scc1 L_loopdone
  s_cmp_eq_u32 s71, 0
  s_cbranch_scc1 L_A_firstV
  s_mov_b64 exec, 1
  global_atomic_add v224, v225, v226, s[68:69] sc0 sc1
  s_mov_b64 exec, -1
  s_add_u32 s63, s62, 4096
  buffer_load_dwordx4 v[192:195], v3, s[36:39], s62 offen offset:0 nt
  buffer_load_dwordx4 v[196:199], v3, s[36:39], s62 offen offset:1024 nt
  buffer_load_dwordx4 v[200:203], v3, s[36:39], s62 offen offset:2048 nt
  buffer_load_dwordx4 v[204:207], v3, s[36:39], s62 offen offset:3072 nt
  buffer_load_dwordx4 v[208:211], v3, s[36:39], s63 offen offset:0 nt
  buffer_load_dwordx4 v[212:215], v3, s[36:39], s63 offen offset:1024 nt
  buffer_load_dwordx4 v[216:219], v3, s[36:39], s63 offen offset:2048 nt
  buffer_load_dwordx4 v[220:223], v3, s[36:39], s63 offen offset:3072 nt
  s_branch L_bodyB
L_A_firstV:
  s_mov_b64 exec, 1
  global_atomic_add v224, v225, v226, s[68:69] sc0 sc1
  s_mov_b64 exec, -1
  s_add_u32 s61, s60, 4096
  buffer_load_dwordx4 v[128:131], v3, s[36:39], s60 offen offset:0 nt
  buffer_load_dwordx4 v[132:135], v3, s[36:39], s60 offen offset:1024 nt
  buffer_load_dwordx4 v[136:139], v3, s[36:39], s60 offen offset:2048 nt
  buffer_load_dwordx4 v[140:143], v3, s[36:39], s60 offen offset:3072 nt
  buffer_load_dwordx4 v[144:147], v3, s[36:39], s61 offen offset:0 nt
  buffer_load_dwordx4 v[148:151], v3, s[36:39], s61 offen offset:1024 nt
  buffer_load_dwordx4 v[152:155], v3, s[36:39], s61 offen offset:2048 nt
  buffer_load_dwordx4 v[156:159], v3, s[36:39], s61 offen offset:3072 nt
  s_mov_b32 s71, 1
L_bodyB:
  s_cmp_eq_u32 s71, 1
  s_cbranch_scc1 L_B_first1
  s_waitcnt vmcnt(8)
  v_readfirstlane_b32 s46, v224
  s_nop 0
  s_add_u32 s46, s46, 192
  s_cmp_ge_u32 s46, 1024
  s_cbranch_scc1 L_B_done
  s_lshl_b32 s60, s46, 13
  s_add_u32 s61, s60, 4096
  buffer_load_dwordx4 v[96:99], v2, s[32:35], s60 offen offset:0 nt
  buffer_load_dwordx4 v[100:103], v2, s[32:35], s60 offen offset:1024 nt
  buffer_load_dwordx4 v[104:107], v2, s[32:35], s60 offen offset:2048 nt
  buffer_load_dwordx4 v[108:111], v2, s[32:35], s60 offen offset:3072 nt
  buffer_load_dwordx4 v[112:115], v2, s[32:35], s61 offen offset:0 nt
  buffer_load_dwordx4 v[116:119], v2, s[32:35], s61 offen offset:1024 nt
  buffer_load_dwordx4 v[120:123], v2, s[32:35], s61 offen offset:2048 nt
  buffer_load_dwordx4 v[124:127], v2, s[32:35], s61 offen offset:3072 nt
  s_branch L_B_qk
L_B_done:
  s_mov_b32 s65, 1
L_B_first1:
L_B_qk:
  v_mfma_f32_16x16x32_bf16 v[64:67], v[160:163], v[4:7], 0
  v_mfma_f32_16x16x32_bf16 v[68:71], v[164:167], v[4:7], 0
  v_mfma_f32_16x16x32_bf16 v[72:75], v[168:171], v[4:7], 0
  v_mfma_f32_16x16x32_bf16 v[76:79], v[172:175], v[4:7], 0
  v_mfma_f32_16x16x32_bf16 v[80:83], v[176:179], v[4:7], 0
  v_mfma_f32_16x16x32_bf16 v[84:87], v[180:183], v[4:7], 0
  v_mfma_f32_16x16x32_bf16 v[88:91], v[184:187], v[4:7], 0
  v_mfma_f32_16x16x32_bf16 v[92:95], v[188:191], v[4:7], 0
  s_nop 0
  v_add_f32_dpp v16, v65, v64 row_shl:4 row_mask:0xf bank_mask:0xf bound_ctrl:0
  v_add_f32_dpp v17, v69, v68 row_shl:4 row_mask:0xf bank_mask:0xf bound_ctrl:0
  v_add_f32_dpp v18, v73, v72 row_shl:4 row_mask:0xf bank_mask:0xf bound_ctrl:0
  v_add_f32_dpp v19, v77, v76 row_shl:4 row_mask:0xf bank_mask:0xf bound_ctrl:0
  v_add_f32_dpp v20, v81, v80 row_shl:4 row_mask:0xf bank_mask:0xf bound_ctrl:0
  v_add_f32_dpp v21, v85, v84 row_shl:4 row_mask:0xf bank_mask:0xf bound_ctrl:0
  v_add_f32_dpp v22, v89, v88 row_shl:4 row_mask:0xf bank_mask:0xf bound_ctrl:0
  v_add_f32_dpp v23, v93, v92 row_shl:4 row_mask:0xf bank_mask:0xf bound_ctrl:0
  v_add_f32_dpp v16, v66, v16 row_shl:8 row_mask:0xf bank_mask:0xf bound_ctrl:0
  v_add_f32_dpp v17, v70, v17 row_shl:8 row_mask:0xf bank_mask:0xf bound_ctrl:0
  v_add_f32_dpp v18, v74, v18 row_shl:8 row_mask:0xf bank_mask:0xf bound_ctrl:0
  v_add_f32_dpp v19, v78, v19 row_shl:8 row_mask:0xf bank_mask:0xf bound_ctrl:0
  v_add_f32_dpp v20, v82, v20 row_shl:8 row_mask:0xf bank_mask:0xf bound_ctrl:0
  v_add_f32_dpp v21, v86, v21 row_shl:8 row_mask:0xf bank_mask:0xf bound_ctrl:0
  v_add_f32_dpp v22, v90, v22 row_shl:8 row_mask:0xf bank_mask:0xf bound_ctrl:0
  v_add_f32_dpp v23, v94, v23 row_shl:8 row_mask:0xf bank_mask:0xf bound_ctrl:0
  v_add_f32_dpp v16, v67, v16 row_shl:12 row_mask:0xf bank_mask:0xf bound_ctrl:0
  v_add_f32_dpp v17, v71, v17 row_shl:12 row_mask:0xf bank_mask:0xf bound_ctrl:0
  v_add_f32_dpp v18, v75, v18 row_shl:12 row_mask:0xf bank_mask:0xf bound_ctrl:0
  v_add_f32_dpp v19, v79, v19 row_shl:12 row_mask:0xf bank_mask:0xf bound_ctrl:0
  v_add_f32_dpp v20, v83, v20 row_shl:12 row_mask:0xf bank_mask:0xf bound_ctrl:0
  v_add_f32_dpp v21, v87, v21 row_shl:12 row_mask:0xf bank_mask:0xf bound_ctrl:0
  v_add_f32_dpp v22, v91, v22 row_shl:12 row_mask:0xf bank_mask:0xf bound_ctrl:0
  v_add_f32_dpp v23, v95, v23 row_shl:12 row_mask:0xf bank_mask:0xf bound_ctrl:0
  v_cvt_pk_bf16_f32 v28, v16, v17
  v_cvt_pk_bf16_f32 v29, v18, v19
  v_cvt_pk_bf16_f32 v30, v20, v21
  v_cvt_pk_bf16_f32 v31, v22, v23
  v_lshlrev_b32 v16, 16, v28
  v_and_b32 v17, s56, v28
  v_lshlrev_b32 v18, 16, v29
  v_and_b32 v19, s56, v29
  v_lshlrev_b32 v20, 16, v30
  v_and_b32 v21, s56, v30
  v_lshlrev_b32 v22, 16, v31
  v_and_b32 v23, s56, v31
  v_mul_f32 v16, s52, v16
  v_mul_f32 v17, s52, v17
  v_mul_f32 v18, s52, v18
  v_mul_f32 v19, s52, v19
  v_mul_f32 v20, s52, v20
  v_mul_f32 v21, s52, v21
  v_mul_f32 v22, s52, v22
  v_mul_f32 v23, s52, v23
  v_cvt_pk_bf16_f32 v28, v16, v17
  v_cvt_pk_bf16_f32 v29, v18, v19
  v_cvt_pk_bf16_f32 v30, v20, v21
  v_cvt_pk_bf16_f32 v31, v22, v23
  v_lshlrev_b32 v16, 16, v28
  v_and_b32 v17, s56, v28
  v_lshlrev_b32 v18, 16, v29
  v_and_b32 v19, s56, v29
  v_lshlrev_b32 v20, 16, v30
  v_and_b32 v21, s56, v30
  v_lshlrev_b32 v22, 16, v31
  v_and_b32 v23, s56, v31
  v_max3_f32 v10, v16, v17, v8
  v_max3_f32 v13, v18, v19, v20
  v_max3_f32 v14, v21, v22, v23
  v_max3_f32 v10, v10, v13, v14
  v_sub_f32 v11, v8, v10
  v_mul_f32 v12, s53, v10
  v_mul_f32 v11, s53, v11
  v_mov_b32 v8, v10
  v_exp_f32 v11, v11
  v_fma_f32 v16, v16, s53, -v12
  v_fma_f32 v17, v17, s53, -v12
  v_fma_f32 v18, v18, s53, -v12
  v_fma_f32 v19, v19, s53, -v12
  v_fma_f32 v20, v20, s53, -v12
  v_fma_f32 v21, v21, s53, -v12
  v_fma_f32 v22, v22, s53, -v12
  v_fma_f32 v23, v23, s53, -v12
  v_exp_f32 v16, v16
  v_exp_f32 v17, v17
  v_exp_f32 v18, v18
  v_exp_f32 v19, v19
  v_exp_f32 v20, v20
  v_exp_f32 v21, v21
  v_exp_f32 v22, v22
  v_exp_f32 v23, v23
  v_mul_f32_dpp v32, v11, v32 row_newbcast:0 row_mask:0xf bank_mask:0xf
  v_mul_f32_dpp v33, v11, v33 row_newbcast:1 row_mask:0xf bank_mask:0xf
  v_mul_f32_dpp v34, v11, v34 row_newbcast:2 row_mask:0xf bank_mask:0xf
  v_mul_f32_dpp v35, v11, v35 row_newbcast:3 row_mask:0xf bank_mask:0xf
  v_mul_f32_dpp v36, v11, v36 row_newbcast:0 row_mask:0xf bank_mask:0xf
  v_mul_f32_dpp v37, v11, v37 row_newbcast:1 row_mask:0xf bank_mask:0xf
  v_mul_f32_dpp v38, v11, v38 row_newbcast:2 row_mask:0xf bank_mask:0xf
  v_mul_f32_dpp v39, v11, v39 row_newbcast:3 row_mask:0xf bank_mask:0xf
  v_mul_f32_dpp v40, v11, v40 row_newbcast:0 row_mask:0xf bank_mask:0xf
  v_mul_f32_dpp v41, v11, v41 row_newbcast:1 row_mask:0xf bank_mask:0xf
  v_mul_f32_dpp v42, v11, v42 row_newbcast:2 row_mask:0xf bank_mask:0xf
  v_mul_f32_dpp v43, v11, v43 row_newbcast:3 row_mask:0xf bank_mask:0xf
  v_mul_f32_dpp v44, v11, v44 row_newbcast:0 row_mask:0xf bank_mask:0xf
  v_mul_f32_dpp v45, v11, v45 row_newbcast:1 row_mask:0xf bank_mask:0xf
  v_mul_f32_dpp v46, v11, v46 row_newbcast:2 row_mask:0xf bank_mask:0xf
  v_mul_f32_dpp v47, v11, v47 row_newbcast:3 row_mask:0xf bank_mask:0xf
  v_mul_f32_dpp v48, v11, v48 row_newbcast:0 row_mask:0xf bank_mask:0xf
  v_mul_f32_dpp v49, v11, v49 row_newbcast:1 row_mask:0xf bank_mask:0xf
  v_mul_f32_dpp v50, v11, v50 row_newbcast:2 row_mask:0xf bank_mask:0xf
  v_mul_f32_dpp v51, v11, v51 row_newbcast:3 row_mask:0xf bank_mask:0xf
  v_mul_f32_dpp v52, v11, v52 row_newbcast:0 row_mask:0xf bank_mask:0xf
  v_mul_f32_dpp v53, v11, v53 row_newbcast:1 row_mask:0xf bank_mask:0xf
  v_mul_f32_dpp v54, v11, v54 row_newbcast:2 row_mask:0xf bank_mask:0xf
  v_mul_f32_dpp v55, v11, v55 row_newbcast:3 row_mask:0xf bank_mask:0xf
  v_mul_f32_dpp v56, v11, v56 row_newbcast:0 row_mask:0xf bank_mask:0xf
  v_mul_f32_dpp v57, v11, v57 row_newbcast:1 row_mask:0xf bank_mask:0xf
  v_mul_f32_dpp v58, v11, v58 row_newbcast:2 row_mask:0xf bank_mask:0xf
  v_mul_f32_dpp v59, v11, v59 row_newbcast:3 row_mask:0xf bank_mask:0xf
  v_mul_f32_dpp v60, v11, v60 row_newbcast:0 row_mask:0xf bank_mask:0xf
  v_mul_f32_dpp v61, v11, v61 row_newbcast:1 row_mask:0xf bank_mask:0xf
  v_mul_f32_dpp v62, v11, v62 row_newbcast:2 row_mask:0xf bank_mask:0xf
  v_mul_f32_dpp v63, v11, v63 row_newbcast:3 row_mask:0xf bank_mask:0xf
  v_cvt_pk_bf16_f32 v24, v16, v17
  v_cvt_pk_bf16_f32 v25, v18, v19
  v_cvt_pk_bf16_f32 v26, v20, v21
  v_cvt_pk_bf16_f32 v27, v22, v23
  v_add_f32 v13, v16, v17
  v_add_f32 v14, v18, v19
  v_add_f32 v15, v20, v21
  v_add_f32 v10, v22, v23
  v_add_f32 v13, v13, v14
  v_add_f32 v15, v15, v10
  v_add_f32 v13, v13, v15
  v_fma_f32 v9, v9, v11, v13
  s_cmp_eq_u32 s65, 1
  s_cbranch_scc1 L_B_w0
  s_cmp_eq_u32 s71, 1
  s_cbranch_scc1 L_B_pv
  s_waitcnt vmcnt(8)
  s_branch L_B_pv
L_B_w0:
  s_waitcnt vmcnt(0)
L_B_pv:
  v_perm_b32 v64, v196, v192, s54
  v_perm_b32 v68, v196, v192, s55
  v_perm_b32 v65, v204, v200, s54
  v_perm_b32 v69, v204, v200, s55
  v_perm_b32 v66, v212, v208, s54
  v_perm_b32 v70, v212, v208, s55
  v_perm_b32 v67, v220, v216, s54
  v_perm_b32 v71, v220, v216, s55
  v_perm_b32 v72, v197, v193, s54
  v_perm_b32 v76, v197, v193, s55
  v_perm_b32 v73, v205, v201, s54
  v_perm_b32 v77, v205, v201, s55
  v_perm_b32 v74, v213, v209, s54
  v_perm_b32 v78, v213, v209, s55
  v_perm_b32 v75, v221, v217, s54
  v_perm_b32 v79, v221, v217, s55
  v_mfma_f32_4x4x4_16b_bf16 v[32:35], v[24:25], v[64:65], v[32:35] cbsz:2 abid:0
  v_mfma_f32_4x4x4_16b_bf16 v[36:39], v[24:25], v[68:69], v[36:39] cbsz:2 abid:0
  v_mfma_f32_4x4x4_16b_bf16 v[40:43], v[24:25], v[72:73], v[40:43] cbsz:2 abid:0
  v_mfma_f32_4x4x4_16b_bf16 v[44:47], v[24:25], v[76:77], v[44:47] cbsz:2 abid:0
  v_mfma_f32_4x4x4_16b_bf16 v[32:35], v[26:27], v[66:67], v[32:35] cbsz:2 abid:0
  v_mfma_f32_4x4x4_16b_bf16 v[36:39], v[26:27], v[70:71], v[36:39] cbsz:2 abid:0
  v_mfma_f32_4x4x4_16b_bf16 v[40:43], v[26:27], v[74:75], v[40:43] cbsz:2 abid:0
  v_mfma_f32_4x4x4_16b_bf16 v[44:47], v[26:27], v[78:79], v[44:47] cbsz:2 abid:0
  v_perm_b32 v80, v198, v194, s54
  v_perm_b32 v84, v198, v194, s55
  v_perm_b32 v81, v206, v202, s54
  v_perm_b32 v85, v206, v202, s55
  v_perm_b32 v82, v214, v210, s54
  v_perm_b32 v86, v214, v210, s55
  v_perm_b32 v83, v222, v218, s54
  v_perm_b32 v87, v222, v218, s55
  v_perm_b32 v88, v199, v195, s54
  v_perm_b32 v92, v199, v195, s55
  v_perm_b32 v89, v207, v203, s54
  v_perm_b32 v93, v207, v203, s55
  v_perm_b32 v90, v215, v211, s54
  v_perm_b32 v94, v215, v211, s55
  v_perm_b32 v91, v223, v219, s54
  v_perm_b32 v95, v223, v219, s55
  v_mfma_f32_4x4x4_16b_bf16 v[48:51], v[24:25], v[80:81], v[48:51] cbsz:2 abid:0
  v_mfma_f32_4x4x4_16b_bf16 v[52:55], v[24:25], v[84:85], v[52:55] cbsz:2 abid:0
  v_mfma_f32_4x4x4_16b_bf16 v[56:59], v[24:25], v[88:89], v[56:59] cbsz:2 abid:0
  v_mfma_f32_4x4x4_16b_bf16 v[60:63], v[24:25], v[92:93], v[60:63] cbsz:2 abid:0
  v_mfma_f32_4x4x4_16b_bf16 v[48:51], v[26:27], v[82:83], v[48:51] cbsz:2 abid:0
  v_mfma_f32_4x4x4_16b_bf16 v[52:55], v[26:27], v[86:87], v[52:55] cbsz:2 abid:0
  v_mfma_f32_4x4x4_16b_bf16 v[56:59], v[26:27], v[90:91], v[56:59] cbsz:2 abid:0
  v_mfma_f32_4x4x4_16b_bf16 v[60:63], v[26:27], v[94:95], v[60:63] cbsz:2 abid:0
  s_cmp_eq_u32 s65, 1
  s_cbranch_scc1 L_loopdone
  s_cmp_eq_u32 s71, 1
  s_cbranch_scc1 L_B_firstV
  s_mov_b64 exec, 1
  global_atomic_add v224, v225, v226, s[68:69] sc0 sc1
  s_mov_b64 exec, -1
  s_add_u32 s61, s60, 4096
  buffer_load_dwordx4 v[128:131], v3, s[36:39], s60 offen offset:0 nt
  buffer_load_dwordx4 v[132:135], v3, s[36:39], s60 offen offset:1024 nt
  buffer_load_dwordx4 v[136:139], v3, s[36:39], s60 offen offset:2048 nt
  buffer_load_dwordx4 v[140:143], v3, s[36:39], s60 offen offset:3072 nt
  buffer_load_dwordx4 v[144:147], v3, s[36:39], s61 offen offset:0 nt
  buffer_load_dwordx4 v[148:151], v3, s[36:39], s61 offen offset:1024 nt
  buffer_load_dwordx4 v[152:155], v3, s[36:39], s61 offen offset:2048 nt
  buffer_load_dwordx4 v[156:159], v3, s[36:39], s61 offen offset:3072 nt
  s_branch L_bodyA
L_B_firstV:
  s_mov_b32 s71, 2
  s_branch L_bodyA
L_loopdone:
  s_cmp_eq_u32 s67, 1
  s_cbranch_scc1 L_dryloop_ret
L_chain_t_0:
  s_cbranch_execz L_chain_t_1
  v_mov_b32 v10, v8
L_chain_t_1:
  s_cbranch_execz L_chain_t_2
  v_mov_b32 v11, v10
  s_nop 1
  v_permlane32_swap_b32 v10, v11
  v_max_f32 v10, v10, v11
  v_mov_b32 v11, v10
  s_nop 1
  v_permlane16_swap_b32 v10, v11
  v_max_f32 v10, v10, v11
  v_sub_f32 v12, v8, v10
  v_mul_f32 v12, s53, v12
  v_exp_f32 v12, v12
  s_nop 0
  v_mul_f32 v9, v9, v12
  v_mul_f32_dpp v32, v12, v32 row_newbcast:0 row_mask:0xf bank_mask:0xf
L_chain_t_2:
  s_cbranch_execz L_chain_t_3
  v_mul_f32_dpp v33, v12, v33 row_newbcast:1 row_mask:0xf bank_mask:0xf
  v_mul_f32_dpp v34, v12, v34 row_newbcast:2 row_mask:0xf bank_mask:0xf
  v_mul_f32_dpp v35, v12, v35 row_newbcast:3 row_mask:0xf bank_mask:0xf
  v_mul_f32_dpp v36, v12, v36 row_newbcast:0 row_mask:0xf bank_mask:0xf
  v_mul_f32_dpp v37, v12, v37 row_newbcast:1 row_mask:0xf bank_mask:0xf
  v_mul_f32_dpp v38, v12, v38 row_newbcast:2 row_mask:0xf bank_mask:0xf
  v_mul_f32_dpp v39, v12, v39 row_newbcast:3 row_mask:0xf bank_mask:0xf
  v_mul_f32_dpp v40, v12, v40 row_newbcast:0 row_mask:0xf bank_mask:0xf
L_chain_t_3:
  s_cbranch_execz L_chain_t_4
  v_mul_f32_dpp v41, v12, v41 row_newbcast:1 row_mask:0xf bank_mask:0xf
  v_mul_f32_dpp v42, v12, v42 row_newbcast:2 row_mask:0xf bank_mask:0xf
  v_mul_f32_dpp v43, v12, v43 row_newbcast:3 row_mask:0xf bank_mask:0xf
  v_mul_f32_dpp v44, v12, v44 row_newbcast:0 row_mask:0xf bank_mask:0xf
  v_mul_f32_dpp v45, v12, v45 row_newbcast:1 row_mask:0xf bank_mask:0xf
  v_mul_f32_dpp v46, v12, v46 row_newbcast:2 row_mask:0xf bank_mask:0xf
  v_mul_f32_dpp v47, v12, v47 row_newbcast:3 row_mask:0xf bank_mask:0xf
L_chain_t_4:
  s_cbranch_execz L_chain_t_5
  v_mul_f32_dpp v48, v12, v48 row_newbcast:0 row_mask:0xf bank_mask:0xf
  v_mul_f32_dpp v49, v12, v49 row_newbcast:1 row_mask:0xf bank_mask:0xf
  v_mul_f32_dpp v50, v12, v50 row_newbcast:2 row_mask:0xf bank_mask:0xf
  v_mul_f32_dpp v51, v12, v51 row_newbcast:3 row_mask:0xf bank_mask:0xf
  v_mul_f32_dpp v52, v12, v52 row_newbcast:0 row_mask:0xf bank_mask:0xf
  v_mul_f32_dpp v53, v12, v53 row_newbcast:1 row_mask:0xf bank_mask:0xf
  v_mul_f32_dpp v54, v12, v54 row_newbcast:2 row_mask:0xf bank_mask:0xf
  v_mul_f32_dpp v55, v12, v55 row_newbcast:3 row_mask:0xf bank_mask:0xf
L_chain_t_5:
  s_cbranch_execz L_chain_t_6
  v_mul_f32_dpp v56, v12, v56 row_newbcast:0 row_mask:0xf bank_mask:0xf
  v_mul_f32_dpp v57, v12, v57 row_newbcast:1 row_mask:0xf bank_mask:0xf
  v_mul_f32_dpp v58, v12, v58 row_newbcast:2 row_mask:0xf bank_mask:0xf
  v_mul_f32_dpp v59, v12, v59 row_newbcast:3 row_mask:0xf bank_mask:0xf
  v_mul_f32_dpp v60, v12, v60 row_newbcast:0 row_mask:0xf bank_mask:0xf
  v_mul_f32_dpp v61, v12, v61 row_newbcast:1 row_mask:0xf bank_mask:0xf
  v_mul_f32_dpp v62, v12, v62 row_newbcast:2 row_mask:0xf bank_mask:0xf
L_chain_t_6:
  s_cbranch_execz L_chain_t_7
  v_mul_f32_dpp v63, v12, v63 row_newbcast:3 row_mask:0xf bank_mask:0xf
  v_mov_b32 v11, v9
  s_nop 1
  v_permlane32_swap_b32 v9, v11
  v_add_f32 v9, v9, v11
  v_mov_b32 v11, v9
  s_nop 1
  v_permlane16_swap_b32 v9, v11
  v_add_f32 v9, v9, v11
  v_permlane32_swap_b32 v32, v34
  v_permlane32_swap_b32 v33, v35
  v_permlane32_swap_b32 v36, v38
  v_permlane32_swap_b32 v37, v39
  v_permlane32_swap_b32 v40, v42
L_chain_t_7:
  s_cbranch_execz L_chain_t_8
  v_permlane32_swap_b32 v41, v43
  v_permlane32_swap_b32 v44, v46
  v_permlane32_swap_b32 v45, v47
  v_permlane32_swap_b32 v48, v50
  v_permlane32_swap_b32 v49, v51
  v_permlane32_swap_b32 v52, v54
  v_permlane32_swap_b32 v53, v55
  v_permlane32_swap_b32 v56, v58
  v_permlane32_swap_b32 v57, v59
  v_permlane32_swap_b32 v60, v62
  v_permlane32_swap_b32 v61, v63
  v_add_f32 v32, v32, v34
  v_add_f32 v33, v33, v35
  v_add_f32 v36, v36, v38
  v_add_f32 v37, v37, v39
L_chain_t_8:
  s_cbranch_execz L_chain_t_9
  v_add_f32 v40, v40, v42
  v_add_f32 v41, v41, v43
  v_add_f32 v44, v44, v46
  v_add_f32 v45, v45, v47
  v_add_f32 v48, v48, v50
  v_add_f32 v49, v49, v51
  v_add_f32 v52, v52, v54
  v_add_f32 v53, v53, v55
  v_add_f32 v56, v56, v58
  v_add_f32 v57, v57, v59
  v_add_f32 v60, v60, v62
  v_add_f32 v61, v61, v63
  v_permlane16_swap_b32 v32, v33
  v_permlane16_swap_b32 v36, v37
  v_permlane16_swap_b32 v40, v41
L_chain_t_9:
  s_cbranch_execz L_chain_t_10
  v_permlane16_swap_b32 v44, v45
  v_permlane16_swap_b32 v48, v49
  v_permlane16_swap_b32 v52, v53
  v_permlane16_swap_b32 v56, v57
  v_permlane16_swap_b32 v60, v61
  v_add_f32 v64, v32, v33
  v_add_f32 v65, v36, v37
  v_add_f32 v66, v40, v41
  v_add_f32 v67, v44, v45
  v_add_f32 v68, v48, v49
  v_add_f32 v69, v52, v53
  v_add_f32 v70, v56, v57
  v_add_f32 v71, v60, v61
  s_lshl_b32 s46, s31, 11
  s_add_u32 s46, s46, 70656
L_chain_t_10:
  s_cbranch_execz L_chain_t_11
  v_lshlrev_b32 v13, 5, v1
  v_add_u32 v13, s46, v13
  ds_write_b128 v13, v[64:67]
  ds_write_b128 v13, v[68:71] offset:16
  v_mov_b32 v14, v10
  v_mov_b32 v15, v9
  s_lshl_b32 s46, s31, 5
  s_add_u32 s46, s46, 4096
  v_lshlrev_b32 v13, 3, v1
  v_add_u32 v13, s46, v13
  s_mov_b64 exec, 0xf
L_chain_t_11:
  s_cbranch_execz L_chain_t_12
  ds_write_b64 v13, v[14:15]
  s_mov_b64 exec, -1
  s_waitcnt lgkmcnt(0)
  s_branch L_t1_join
L_t1_h:
  s_waitcnt vmcnt(0)
L_t1_join:
  s_barrier
  v_lshlrev_b32 v13, 2, v0
  v_add_u32 v13, 70656, v13
  ds_read2st64_b32 v[64:65], v13 offset0:0 offset1:8
  ds_read2st64_b32 v[66:67], v13 offset0:16 offset1:24
  s_lshr_b32 s46, s31, 1
L_chain_t_12:
  s_cbranch_execz L_chain_t_13
  s_lshl_b32 s46, s46, 3
  s_add_u32 s46, s46, 4096
  v_mov_b32 v14, s46
  ds_read_b64 v[72:73], v14 offset:0
  ds_read_b64 v[74:75], v14 offset:32
  ds_read_b64 v[76:77], v14 offset:64
  ds_read_b64 v[78:79], v14 offset:96
  s_lshl_b32 s46, s40, 4
  s_add_u32 s46, s46, s41
  s_lshl_b32 s46, s46, 12
L_chain_t_13:
  s_cbranch_execz L_chain_t_14
  s_add_u32 s46, s46, 1048576
  v_lshlrev_b32 v13, 3, v0
  v_add_u32 v13, s46, v13
  s_waitcnt lgkmcnt(0)
  v_max3_f32 v10, v72, v74, v76
  v_max_f32 v10, v10, v78
  v_sub_f32 v72, v72, v10
  v_sub_f32 v74, v74, v10
  v_sub_f32 v76, v76, v10
  v_sub_f32 v78, v78, v10
  v_mul_f32 v72, s53, v72
  v_mul_f32 v74, s53, v74
  v_mul_f32 v76, s53, v76
L_chain_t_14:
  s_cbranch_execz L_chain_t_15
  v_mul_f32 v78, s53, v78
  v_exp_f32 v72, v72
  v_exp_f32 v74, v74
  v_exp_f32 v76, v76
  v_exp_f32 v78, v78
  v_mul_f32 v16, v72, v64
  v_mul_f32 v18, v72, v73
  v_fmac_f32 v16, v74, v65
  v_fmac_f32 v18, v74, v75
  v_fmac_f32 v16, v76, v66
  v_fmac_f32 v18, v76, v77
  v_fmac_f32 v16, v78, v67
  v_fmac_f32 v18, v78, v79
  s_nop 0
  v_mov_b32_dpp v26, v16 quad_perm:[1,0,3,2] row_mask:0xf bank_mask:0xf
L_chain_t_15:
  s_cbranch_execz L_chain_t_16
  v_mov_b32 v24, v16
  v_mov_b32 v25, s30
  v_mov_b32 v27, s30
  s_mov_b32 exec_lo, 0x55555555
  s_mov_b32 exec_hi, 0x55555555
  global_store_dwordx4 v13, v[24:27], s[28:29] offset:0 sc1
  s_mov_b64 exec, -1
  s_bitcmp1_b32 s31, 0
  s_cbranch_scc1 L_noml
  v_mov_b32 v20, v10
  v_mov_b32 v21, s30
L_chain_t_16:
  s_cbranch_execz L_chain_t_17
  v_mov_b32 v22, v18
  v_mov_b32 v23, s30
  s_lshl_b32 s46, s40, 2
  s_lshr_b32 s47, s31, 1
  s_add_u32 s46, s46, s47
  s_lshl_b32 s46, s46, 8
  s_lshl_b32 s47, s41, 4
  s_add_u32 s46, s46, s47
  s_add_u32 s46, s46, 196608
  v_mov_b32 v13, s46
  s_mov_b64 exec, 1
  global_store_dwordx4 v13, v[20:23], s[28:29] sc1
  s_mov_b64 exec, -1
L_noml:
L_chain_t_17:
  s_cbranch_execz L_chain_t_18
  s_and_b32 s46, s2, 63
  s_lshl_b32 s47, s46, 12
  s_add_u32 s47, s47, 2097152
  v_add_u32 v205, s47, v3
  v_bfe_u32 v26, v1, 2, 1
  v_lshlrev_b32 v26, 10, v26
  v_and_b32 v27, 3, v1
  v_lshl_add_u32 v26, v27, 2, v26
  s_lshl_b32 s46, s46, 4
  v_add_u32 v206, s46, v26
  s_lshr_b32 s46, s31, 2
  s_lshl_b32 s46, s46, 3
L_chain_t_18:
  s_cbranch_execz L_chain_t_19
  s_lshr_b32 s47, s57, 2
  s_add_u32 s65, s46, s47
  s_and_b32 s64, s57, 3
  v_lshrrev_b32 v28, 4, v1
  v_and_b32 v29, 15, v1
  v_xor_b32 v30, v28, v29
  v_lshlrev_b32 v30, 4, v30
  s_lshl_b32 s46, s65, 2
  s_add_u32 s46, s46, s64
  s_lshl_b32 s46, s46, 8
  s_add_u32 s46, s46, 196608
  v_add_u32 v30, s46, v30
  v_lshlrev_b32 v31, 12, v28
  v_lshl_add_u32 v31, v29, 4, v31
L_chain_t_19:
  s_cbranch_execz L_chain_t_20
  s_lshl_b32 s46, s65, 16
  s_lshl_b32 s47, s64, 10
  s_add_u32 s46, s46, s47
  s_and_b32 s47, s31, 3
  s_lshl_b32 s47, s47, 8
  s_add_u32 s46, s46, s47
  s_add_u32 s46, s46, 1048576
  v_add_u32 v24, s46, v31
  v_add_u32 v25, 16384, v24
  v_add_u32 v26, 32768, v24
  v_add_u32 v27, 49152, v24
L_chain_t_20:
  s_cbranch_execz L_chain_t_21
  s_cmp_ge_u32 s31, 4
  s_cbranch_scc1 L_t3nob
  v_bfe_u32 v20, v1, 2, 2
  v_and_b32 v21, 3, v1
  v_lshlrev_b32 v22, 10, v28
  v_lshl_add_u32 v22, v20, 7, v22
  v_lshl_add_u32 v22, v21, 3, v22
  s_lshl_b32 s46, s31, 5
  s_add_u32 s46, s46, 37888
  v_add_u32 v22, s46, v22
L_chain_t_21:
  s_cbranch_execz L_chain_t_22
  ds_read_b64_tr_b16 v[112:113], v22 offset:0
  ds_read_b64_tr_b16 v[114:115], v22 offset:512
  ds_read_b64_tr_b16 v[116:117], v22 offset:4096
  ds_read_b64_tr_b16 v[118:119], v22 offset:4608
  ds_read_b64_tr_b16 v[120:121], v22 offset:8192
  ds_read_b64_tr_b16 v[122:123], v22 offset:8704
  ds_read_b64_tr_b16 v[124:125], v22 offset:12288
  ds_read_b64_tr_b16 v[126:127], v22 offset:12800
L_t3nob:
L_chain_t_22:
  s_cbranch_execz L_chain_t_23
  s_mov_b64 s[62:63], -1
L_t3_poll:
  s_mov_b64 exec, s[62:63]
  global_load_dwordx4 v[160:163], v30, s[28:29] sc1
  global_load_dwordx4 v[164:167], v24, s[28:29] sc1
  global_load_dwordx4 v[168:171], v25, s[28:29] sc1
  global_load_dwordx4 v[172:175], v26, s[28:29] sc1
  global_load_dwordx4 v[176:179], v27, s[28:29] sc1
  s_waitcnt vmcnt(0)
  v_xor_b32 v16, s30, v161
L_chain_t_23:
  s_cbranch_execz L_chain_t_24
  v_xor_b32 v17, s30, v163
  v_xor_b32 v18, s30, v165
  v_or3_b32 v16, v16, v17, v18
  v_xor_b32 v17, s30, v167
  v_xor_b32 v18, s30, v169
  v_or3_b32 v16, v16, v17, v18
  v_xor_b32 v17, s30, v171
  v_xor_b32 v18, s30, v173
  v_or3_b32 v16, v16, v17, v18
  v_xor_b32 v17, s30, v175
  v_xor_b32 v18, s30, v177
  v_or3_b32 v16, v16, v17, v18
L_chain_t_24:
  s_cbranch_execz L_chain_t_25
  v_xor_b32 v17, s30, v179
  v_or_b32 v16, v16, v17
  v_cmp_ne_u32 vcc, 0, v16
  s_nop 0
  s_mov_b64 s[62:63], vcc
  s_cbranch_vccz L_t3_ok
  s_add_u32 s70, s70, 1
  s_cmp_gt_u32 s70, 2000000
  s_cbranch_scc1 L_end
  s_branch L_t3_poll
L_t3_ok:
  s_mov_b64 exec, -1
  v_mov_b32 v16, v160
  s_nop 1
L_chain_t_25:
  s_cbranch_execz L_chain_t_26
  v_max_f32_dpp v16, v16, v16 row_ror:8 row_mask:0xf bank_mask:0xf
  s_nop 1
  v_max_f32_dpp v16, v16, v16 row_ror:4 row_mask:0xf bank_mask:0xf
  s_nop 1
  v_max_f32_dpp v16, v16, v16 row_ror:2 row_mask:0xf bank_mask:0xf
  s_nop 1
  v_max_f32_dpp v16, v16, v16 row_ror:1 row_mask:0xf bank_mask:0xf
  v_sub_f32 v17, v160, v16
  v_mul_f32 v17, s53, v17
  v_exp_f32 v17, v17
  s_nop 0
L_chain_t_26:
  s_cbranch_execz L_chain_t_27
  v_mul_f32 v18, v17, v162
  s_nop 1
  v_add_f32_dpp v18, v18, v18 row_ror:8 row_mask:0xf bank_mask:0xf
  s_nop 1
  v_add_f32_dpp v18, v18, v18 row_ror:4 row_mask:0xf bank_mask:0xf
  s_nop 1
  v_add_f32_dpp v18, v18, v18 row_ror:2 row_mask:0xf bank_mask:0xf
  s_nop 1
  v_add_f32_dpp v18, v18, v18 row_ror:1 row_mask:0xf bank_mask:0xf
  v_rcp_f32 v19, v18
  s_nop 0
L_chain_t_27:
  s_cbranch_execz L_chain_t_28
  v_mul_f32 v20, v17, v19
  v_fma_f32 v18, -v20, v18, v17
  v_fma_f32 v17, v18, v19, v20
  s_nop 1
  v_mul_f32_dpp v20, v17, v164 row_newbcast:0 row_mask:0xf bank_mask:0xf
  v_mul_f32_dpp v21, v17, v166 row_newbcast:0 row_mask:0xf bank_mask:0xf
  s_nop 0
  v_fmac_f32_dpp v20, v17, v168 row_newbcast:4 row_mask:0xf bank_mask:0xf
  v_fmac_f32_dpp v21, v17, v170 row_newbcast:4 row_mask:0xf bank_mask:0xf
L_chain_t_28:
  s_cbranch_execz L_chain_t_29
  s_nop 0
  v_fmac_f32_dpp v20, v17, v172 row_newbcast:8 row_mask:0xf bank_mask:0xf
  v_fmac_f32_dpp v21, v17, v174 row_newbcast:8 row_mask:0xf bank_mask:0xf
  s_nop 0
  v_fmac_f32_dpp v20, v17, v176 row_newbcast:12 row_mask:0xf bank_mask:0xf
  v_fmac_f32_dpp v21, v17, v178 row_newbcast:12 row_mask:0xf bank_mask:0xf
  v_mov_b32 v22, v20
  v_mov_b32 v23, v21
  s_nop 0
  v_permlane32_swap_b32 v20, v22
  v_permlane32_swap_b32 v21, v23
L_chain_t_29:
  s_cbranch_execz L_chain_t_30
  v_add_f32 v20, v20, v22
  v_add_f32 v21, v21, v23
  v_mov_b32 v22, v20
  v_mov_b32 v23, v21
  s_nop 0
  v_permlane16_swap_b32 v20, v22
  v_permlane16_swap_b32 v21, v23
  v_add_f32 v20, v20, v22
  v_add_f32 v21, v21, v23
  v_cvt_pk_bf16_f32 v20, v20, v21
  s_lshr_b32 s46, s31, 2
  s_lshl_b32 s46, s46, 8
  s_and_b32 s47, s31, 3
  s_lshl_b32 s47, s47, 6
L_chain_t_30:
  s_cbranch_execz L_chain_t_31
  s_add_u32 s46, s46, s47
  s_add_u32 s46, s46, 2560
  v_lshlrev_b32 v21, 2, v29
  v_add_u32 v21, s46, v21
  s_mov_b64 exec, 0xffff
  ds_write_b32 v21, v20
  s_mov_b64 exec, -1
  s_lshl_b32 s46, s58, 3
  s_lshl_b32 s47, s31, 1
  s_add_u32 s46, s46, s47
  s_lshl_b32 s46, s46, 12
  s_lshl_b32 s47, s57, 7
L_chain_t_31:
  s_cbranch_execz L_chain_t_32
  s_add_u32 s46, s46, s47
  s_add_u32 s46, s46, 2097152
  v_bfe_u32 v26, v1, 3, 1
  v_lshlrev_b32 v26, 12, v26
  v_bfe_u32 v27, v1, 4, 1
  v_lshl_add_u32 v26, v27, 6, v26
  v_and_b32 v27, 7, v1
  v_lshl_add_u32 v26, v27, 3, v26
  v_add_u32 v26, s46, v26
  v_bfe_u32 v24, v1, 2, 1
L_chain_t_32:
  s_cbranch_execz L_chain_t_33
  v_lshlrev_b32 v24, 8, v24
  v_lshl_add_u32 v24, v28, 4, v24
  s_waitcnt lgkmcnt(0)
  s_barrier
  s_cmp_ge_u32 s31, 4
  s_cbranch_scc1 L_t3done
  ds_read_b128 v[96:99], v24 offset:2560
  ds_read_b128 v[100:103], v24 offset:2624
  ds_read_b128 v[104:107], v24 offset:2688
  ds_read_b128 v[108:111], v24 offset:2752
L_chain_t_33:
  s_cbranch_execz L_chain_t_34
  s_waitcnt lgkmcnt(0)
  v_mfma_f32_16x16x32_bf16 v[224:227], v[96:99], v[112:115], 0
  v_mfma_f32_16x16x32_bf16 v[224:227], v[100:103], v[116:119], v[224:227]
  v_mfma_f32_16x16x32_bf16 v[224:227], v[104:107], v[120:123], v[224:227]
  v_mfma_f32_16x16x32_bf16 v[224:227], v[108:111], v[124:127], v[224:227]
  s_nop 7
  v_mov_b32_dpp v226, v224 quad_perm:[1,0,3,2] row_mask:0xf bank_mask:0xf
  v_mov_b32 v225, s30
  v_mov_b32 v227, s30
L_chain_t_34:
  s_cbranch_execz L_chain_t_35
  s_mov_b32 exec_lo, 0x55555555
  s_mov_b32 exec_hi, 0
  global_store_dwordx4 v26, v[224:227], s[28:29] offset:0 sc1
  s_mov_b64 exec, -1
L_t3done:
  s_cmp_lg_u32 s31, 7
  s_cbranch_scc1 L_fin
  s_cmp_ge_u32 s2, 64
  s_cbranch_scc1 L_fin
  s_mov_b64 s[62:63], -1
L_t4_poll:
  s_mov_b64 exec, s[62:63]
  global_load_dwordx4 v[180:183], v205, s[28:29] offset:0 sc1
  global_load_dwordx4 v[184:187], v205, s[28:29] offset:1024 sc1
L_chain_t_35:
  s_cbranch_execz L_chain_t_36
  global_load_dwordx4 v[188:191], v205, s[28:29] offset:2048 sc1
  global_load_dwordx4 v[192:195], v205, s[28:29] offset:3072 sc1
  s_waitcnt vmcnt(0)
  v_xor_b32 v16, s30, v181
  v_xor_b32 v14, s30, v183
  v_xor_b32 v15, s30, v185
  v_or3_b32 v16, v16, v14, v15
  v_xor_b32 v14, s30, v187
  v_xor_b32 v15, s30, v189
  v_or3_b32 v16, v16, v14, v15
L_chain_t_36:
  s_cbranch_execz L_chain_t_37
  v_xor_b32 v14, s30, v191
  v_xor_b32 v15, s30, v193
  v_or3_b32 v16, v16, v14, v15
  v_xor_b32 v14, s30, v195
  v_or_b32 v16, v16, v14
  v_cmp_ne_u32 vcc, 0, v16
  s_nop 0
  s_mov_b64 s[62:63], vcc
  s_cbranch_vccz L_t4_ok
  s_add_u32 s70, s70, 1
  s_cmp_gt_u32 s70, 2000000
  s_cbranch_scc1 L_fin
  s_branch L_t4_poll
L_t4_ok:
L_chain_t_37:
  s_cbranch_execz L_chain_t_38
  s_mov_b64 exec, -1
  v_add_f32 v20, v180, v184
  v_add_f32 v21, v182, v186
  v_add_f32 v22, v188, v192
  v_add_f32 v23, v190, v194
  v_add_f32 v20, v20, v22
  v_add_f32 v21, v21, v23
  s_nop 0
  v_add_f32_dpp v20, v20, v20 row_ror:8 row_mask:0xf bank_mask:0xf
  v_add_f32_dpp v21, v21, v21 row_ror:8 row_mask:0xf bank_mask:0xf
  v_mov_b32 v14, v20
  v_mov_b32 v15, v21
  s_nop 0
L_chain_t_38:
  s_cbranch_execz L_chain_t_39
  v_permlane32_swap_b32 v20, v14
  v_permlane32_swap_b32 v21, v15
  v_add_f32 v20, v20, v14
  v_add_f32 v21, v21, v15
  v_mov_b32 v14, v20
  v_mov_b32 v15, v21
  s_nop 0
  v_permlane16_swap_b32 v20, v14
  v_permlane16_swap_b32 v21, v15
  v_add_f32 v20, v20, v14
  v_add_f32 v21, v21, v15
  v_cvt_pk_bf16_f32 v22, v20, v21
  v_lshlrev_b32 v20, 16, v22
  v_and_b32 v21, s56, v22
L_chain_t_39:
  s_cbranch_execz L_chain_t_40
  v_mul_f32 v20, v20, v200
  v_mul_f32 v21, v21, v201
  v_cvt_pk_bf16_f32 v22, v20, v21
  v_lshlrev_b32 v20, 16, v22
  v_and_b32 v21, s56, v22
  v_add_f32 v20, v202, v20
  v_add_f32 v21, v203, v21
  v_cvt_pk_bf16_f32 v20, v20, v21
  s_mov_b64 exec, 0xff
  global_store_dword v206, v20, s[24:25]
  s_mov_b64 exec, -1
L_chain_t_40:
  s_cbranch_execz L_chain_t_41
  s_cmp_lg_u32 s2, 0
  s_cbranch_scc1 L_fin
  v_mov_b32 v20, s30
  v_mov_b32 v21, 0
  s_mov_b64 exec, 1
  global_store_dword v21, v20, s[28:29] offset:0 sc1
  s_mov_b64 exec, -1
L_chain_t_41:
  s_cbranch_execz L_chain_ret
L_fin:
L_end:
  s_endpgm
L_helper:
  v_lshlrev_b32 v24, 2, v1
  v_mov_b32 v25, 0
  s_mov_b64 exec, 0xffff
  ds_write_b32 v24, v25 offset:4352
  s_mov_b64 exec, -1
  s_sub_u32 s66, s31, 4
  s_setprio 3
  s_lshr_b32 s3, s2, 3
  s_lshl_b32 s3, s3, 2
  s_and_b32 s46, s2, 3
  s_add_u32 s3, s3, s46
  s_and_b32 s45, s3, 1
  v_lshrrev_b32 v20, 3, v1
  v_and_b32 v21, 7, v1
  v_lshlrev_b32 v21, 4, v21
  s_waitcnt lgkmcnt(0)
  s_load_dwordx8 s[16:23], s[0:1], 32
  s_load_dwordx4 s[24:27], s[0:1], 64
  s_load_dwordx2 s[28:29], s[0:1], 80
  s_barrier
  s_waitcnt lgkmcnt(0)
  s_load_dword s30, s[28:29], 0
  s_mov_b32 s52, 0x3db504f3
  s_mov_b32 s53, 0x3fb8aa3b
  s_mov_b32 s56, 0xffff0000
  s_mov_b32 s54, 0x05040100
  s_mov_b32 s55, 0x07060302
  s_mov_b32 s70, 0
  s_mov_b32 s67, 0
  s_lshr_b32 s42, s40, 3
  s_and_b32 s43, s40, 7
  s_and_b32 s46, s2, 7
  s_lshl_b32 s46, s46, 2
  s_bfe_u32 s47, s2, 0x20003
  s_add_u32 s57, s46, s47
  s_lshr_b32 s58, s2, 5
  s_bitcmp1_b32 s2, 2
  s_cbranch_scc1 L_nonprod
  s_cmp_gt_u32 s66, 1
  s_cbranch_scc1 L_p23
  s_cmp_lg_u32 s66, 0
  s_cbranch_scc1 L_nozero
  s_and_b32 s46, s3, 15
  s_cmp_lg_u32 s46, 0
  s_cbranch_scc1 L_nozero
  s_lshr_b32 s46, s3, 4
  s_lshl_b32 s46, s46, 8
  s_add_u32 s46, s46, 4096
  v_lshlrev_b32 v24, 11, v1
  v_add_u32 v24, s46, v24
  v_mov_b32 v25, 0
  s_mov_b64 exec, 3
  global_store_dword v24, v25, s[28:29] sc1
  s_mov_b64 exec, -1
  s_waitcnt vmcnt(1)
  s_branch L_pgo
L_nozero:
  s_waitcnt vmcnt(0)
L_pgo:
  s_mov_b32 s44, 0
  s_lshl_b32 s46, s66, 10
  s_lshl_b32 s47, s66, 6
  s_add_u32 s47, s47, 5120
  s_lshl_b32 s48, s45, 16
  s_lshr_b32 s50, s3, 1
  s_lshl_b32 s50, s50, 9
  s_add_u32 s48, s48, s50
  s_lshl_b32 s50, s66, 8
  s_add_u32 s48, s48, s50
  s_add_u32 s48, s48, 262144
  s_mov_b32 s49, 32768
  s_mov_b32 s51, 1
L_proj:
  v_lshlrev_b32 v64, 16, v224
  v_lshlrev_b32 v65, 16, v228
  v_and_b32 v66, s56, v224
  v_and_b32 v67, s56, v228
  v_lshlrev_b32 v68, 16, v225
  v_lshlrev_b32 v69, 16, v229
  v_and_b32 v70, s56, v225
  v_and_b32 v71, s56, v229
  v_lshlrev_b32 v72, 16, v226
  v_lshlrev_b32 v73, 16, v230
  v_and_b32 v74, s56, v226
  v_and_b32 v75, s56, v230
  v_lshlrev_b32 v76, 16, v227
  v_lshlrev_b32 v77, 16, v231
  v_and_b32 v78, s56, v227
  v_and_b32 v79, s56, v231
  v_pk_add_f32 v[80:81], v[64:65], v[66:67]
  v_pk_add_f32 v[82:83], v[68:69], v[70:71]
  v_pk_add_f32 v[84:85], v[72:73], v[74:75]
  v_pk_add_f32 v[86:87], v[76:77], v[78:79]
  v_pk_add_f32 v[80:81], v[80:81], v[82:83]
  v_pk_add_f32 v[84:85], v[84:85], v[86:87]
  v_pk_add_f32 v[80:81], v[80:81], v[84:85]
  s_nop 1
  v_add_f32_dpp v80, v80, v80 row_ror:8 row_mask:0xf bank_mask:0xf
  v_add_f32_dpp v81, v81, v81 row_ror:8 row_mask:0xf bank_mask:0xf
  s_nop 0
  v_add_f32_dpp v80, v80, v80 row_ror:4 row_mask:0xf bank_mask:0xf
  v_add_f32_dpp v81, v81, v81 row_ror:4 row_mask:0xf bank_mask:0xf
  s_nop 0
  v_add_f32_dpp v80, v80, v80 row_ror:2 row_mask:0xf bank_mask:0xf
  v_add_f32_dpp v81, v81, v81 row_ror:2 row_mask:0xf bank_mask:0xf
  s_nop 0
  v_add_f32_dpp v80, v80, v80 row_ror:1 row_mask:0xf bank_mask:0xf
  v_add_f32_dpp v81, v81, v81 row_ror:1 row_mask:0xf bank_mask:0xf
  v_mov_b32 v88, v80
  v_mov_b32 v89, v81
  s_nop 0
  v_permlane32_swap_b32 v80, v88
  v_permlane32_swap_b32 v81, v89
  v_add_f32 v80, v80, v88
  v_add_f32 v81, v81, v89
  v_mov_b32 v88, v80
  v_mov_b32 v89, v81
  s_nop 0
  v_permlane16_swap_b32 v80, v88
  v_permlane16_swap_b32 v81, v89
  v_add_f32 v80, v80, v88
  v_add_f32 v81, v81, v89
  v_mul_f32 v90, 0x3b000000, v80
  v_mul_f32 v91, 0x3b000000, v81
  v_pk_add_f32 v[64:65], v[64:65], v[90:91] neg_lo:[0,1] neg_hi:[0,1]
  v_pk_add_f32 v[66:67], v[66:67], v[90:91] neg_lo:[0,1] neg_hi:[0,1]
  v_pk_add_f32 v[68:69], v[68:69], v[90:91] neg_lo:[0,1] neg_hi:[0,1]
  v_pk_add_f32 v[70:71], v[70:71], v[90:91] neg_lo:[0,1] neg_hi:[0,1]
  v_pk_add_f32 v[72:73], v[72:73], v[90:91] neg_lo:[0,1] neg_hi:[0,1]
  v_pk_add_f32 v[74:75], v[74:75], v[90:91] neg_lo:[0,1] neg_hi:[0,1]
  v_pk_add_f32 v[76:77], v[76:77], v[90:91] neg_lo:[0,1] neg_hi:[0,1]
  v_pk_add_f32 v[78:79], v[78:79], v[90:91] neg_lo:[0,1] neg_hi:[0,1]
  v_pk_mul_f32 v[80:81], v[64:65], v[64:65]
  v_pk_mul_f32 v[82:83], v[66:67], v[66:67]
  v_pk_fma_f32 v[80:81], v[68:69], v[68:69], v[80:81]
  v_pk_fma_f32 v[82:83], v[70:71], v[70:71], v[82:83]
  v_pk_fma_f32 v[80:81], v[72:73], v[72:73], v[80:81]
  v_pk_fma_f32 v[82:83], v[74:75], v[74:75], v[82:83]
  v_pk_fma_f32 v[80:81], v[76:77], v[76:77], v[80:81]
  v_pk_fma_f32 v[82:83], v[78:79], v[78:79], v[82:83]
  v_pk_add_f32 v[80:81], v[80:81], v[82:83]
  v_lshlrev_b32 v16, 16, v232
  v_lshlrev_b32 v17, 16, v234
  v_and_b32 v18, s56, v232
  v_and_b32 v19, s56, v234
  v_lshlrev_b32 v20, 16, v233
  v_lshlrev_b32 v21, 16, v235
  v_and_b32 v22, s56, v233
  v_and_b32 v23, s56, v235
  v_add_f32_dpp v80, v80, v80 row_ror:8 row_mask:0xf bank_mask:0xf
  v_add_f32_dpp v81, v81, v81 row_ror:8 row_mask:0xf bank_mask:0xf
  s_nop 0
  v_add_f32_dpp v80, v80, v80 row_ror:4 row_mask:0xf bank_mask:0xf
  v_add_f32_dpp v81, v81, v81 row_ror:4 row_mask:0xf bank_mask:0xf
  s_nop 0
  v_add_f32_dpp v80, v80, v80 row_ror:2 row_mask:0xf bank_mask:0xf
  v_add_f32_dpp v81, v81, v81 row_ror:2 row_mask:0xf bank_mask:0xf
  s_nop 0
  v_add_f32_dpp v80, v80, v80 row_ror:1 row_mask:0xf bank_mask:0xf
  v_add_f32_dpp v81, v81, v81 row_ror:1 row_mask:0xf bank_mask:0xf
  v_mov_b32 v88, v80
  v_mov_b32 v89, v81
  s_nop 0
  v_permlane32_swap_b32 v80, v88
  v_permlane32_swap_b32 v81, v89
  v_add_f32 v80, v80, v88
  v_add_f32 v81, v81, v89
  v_mov_b32 v88, v80
  v_mov_b32 v89, v81
  s_nop 0
  v_permlane16_swap_b32 v80, v88
  v_permlane16_swap_b32 v81, v89
  v_add_f32 v80, v80, v88
  v_add_f32 v81, v81, v89
  v_mul_f32 v80, 0x3b000000, v80
  v_mul_f32 v81, 0x3b000000, v81
  v_cvt_pk_bf16_f32 v64, v90, v91
  v_lshlrev_b32 v90, 16, v64
  v_and_b32 v91, s56, v64
  v_cvt_pk_bf16_f32 v65, v80, v81
  v_lshlrev_b32 v80, 16, v65
  v_and_b32 v81, s56, v65
  v_add_f32 v80, 0x3727c5ac, v80
  v_add_f32 v81, 0x3727c5ac, v81
  v_pk_add_f32 v[16:17], v[16:17], v[90:91] neg_lo:[0,1] neg_hi:[0,1]
  v_pk_add_f32 v[18:19], v[18:19], v[90:91] neg_lo:[0,1] neg_hi:[0,1]
  v_pk_add_f32 v[20:21], v[20:21], v[90:91] neg_lo:[0,1] neg_hi:[0,1]
  v_pk_add_f32 v[22:23], v[22:23], v[90:91] neg_lo:[0,1] neg_hi:[0,1]
  v_cvt_pk_bf16_f32 v65, v80, v81
  v_lshlrev_b32 v80, 16, v65
  v_and_b32 v81, s56, v65
  v_sqrt_f32 v80, v80
  v_sqrt_f32 v81, v81
  v_cvt_pk_bf16_f32 v66, v16, v17
  v_lshlrev_b32 v16, 16, v66
  v_and_b32 v17, s56, v66
  v_cvt_pk_bf16_f32 v67, v18, v19
  v_lshlrev_b32 v18, 16, v67
  v_and_b32 v19, s56, v67
  v_cvt_pk_bf16_f32 v68, v20, v21
  v_lshlrev_b32 v20, 16, v68
  v_and_b32 v21, s56, v68
  v_cvt_pk_bf16_f32 v69, v22, v23
  v_lshlrev_b32 v22, 16, v69
  v_and_b32 v23, s56, v69
  v_cvt_pk_bf16_f32 v65, v80, v81
  v_lshlrev_b32 v80, 16, v65
  v_and_b32 v81, s56, v65
  v_rcp_f32 v72, v80
  v_rcp_f32 v73, v81
  s_nop 0
  v_pk_mul_f32 v[64:65], v[16:17], v[72:73]
  v_pk_mul_f32 v[66:67], v[18:19], v[72:73]
  v_pk_mul_f32 v[68:69], v[20:21], v[72:73]
  v_pk_mul_f32 v[70:71], v[22:23], v[72:73]
  v_pk_fma_f32 v[16:17], v[64:65], v[80:81], v[16:17] neg_lo:[1,0,0] neg_hi:[1,0,0]
  v_pk_fma_f32 v[18:19], v[66:67], v[80:81], v[18:19] neg_lo:[1,0,0] neg_hi:[1,0,0]
  v_pk_fma_f32 v[20:21], v[68:69], v[80:81], v[20:21] neg_lo:[1,0,0] neg_hi:[1,0,0]
  v_pk_fma_f32 v[22:23], v[70:71], v[80:81], v[22:23] neg_lo:[1,0,0] neg_hi:[1,0,0]
  v_pk_fma_f32 v[64:65], v[16:17], v[72:73], v[64:65]
  v_pk_fma_f32 v[66:67], v[18:19], v[72:73], v[66:67]
  v_pk_fma_f32 v[68:69], v[20:21], v[72:73], v[68:69]
  v_pk_fma_f32 v[70:71], v[22:23], v[72:73], v[70:71]
  v_cvt_pk_bf16_f32 v16, v64, v66
  v_cvt_pk_bf16_f32 v17, v68, v70
  v_cvt_pk_bf16_f32 v18, v65, v67
  v_cvt_pk_bf16_f32 v19, v69, v71
  v_lshlrev_b32 v24, 3, v1
  v_add_u32 v24, s46, v24
  ds_write_b64 v24, v[16:17] offset:0
  ds_write_b64 v24, v[18:19] offset:512
  v_bfe_u32 v24, v1, 2, 1
  v_lshlrev_b32 v24, 9, v24
  v_lshl_add_u32 v24, v28, 4, v24
  v_add_u32 v24, s46, v24
  v_lshlrev_b32 v25, 10, v28
  v_lshl_add_u32 v25, v29, 7, v25
  v_lshl_add_u32 v25, v30, 3, v25
  v_add_u32 v25, s47, v25
  v_bfe_u32 v26, v1, 4, 1
  v_mul_lo_u32 v26, v26, s49
  v_and_b32 v27, 15, v1
  v_lshl_add_u32 v26, v27, 3, v26
  v_add_u32 v26, s48, v26
  s_waitcnt vmcnt(0) lgkmcnt(0)
  s_cmp_lg_u32 s44, 0
  s_cbranch_scc1 L_pj_wok
  s_mul_i32 s30, s30, 0x9e3779b1
  s_add_u32 s30, s30, 0x85ebca6b
  v_mov_b32 v23, 4368
L_pj_spin:
  ds_read_b128 v[224:227], v23
  s_waitcnt lgkmcnt(0)
  v_and_b32 v224, v224, v225
  v_and_b32 v226, v226, v227
  v_and_b32 v224, v224, v226
  v_cmp_ne_u32 vcc, 1, v224
  s_cbranch_vccz L_pj_wok
  s_add_u32 s70, s70, 1
  s_cmp_gt_u32 s70, 2000000
  s_cbranch_scc1 L_end
  s_branch L_pj_spin
L_pj_wok:
L_pj_pair:
  ds_read_b128 v[96:99], v24 offset:0
  ds_read_b128 v[100:103], v24 offset:64
  ds_read_b128 v[104:107], v24 offset:128
  ds_read_b128 v[108:111], v24 offset:192
  ds_read_b128 v[112:115], v24 offset:256
  ds_read_b128 v[116:119], v24 offset:320
  ds_read_b128 v[120:123], v24 offset:384
  ds_read_b128 v[124:127], v24 offset:448
  s_waitcnt lgkmcnt(7)
  ds_read_b64_tr_b16 v[128:129], v25 offset:0
  ds_read_b64_tr_b16 v[130:131], v25 offset:512
  ds_read_b64_tr_b16 v[132:133], v25 offset:4096
  ds_read_b64_tr_b16 v[134:135], v25 offset:4608
  ds_read_b64_tr_b16 v[136:137], v25 offset:8192
  ds_read_b64_tr_b16 v[138:139], v25 offset:8704
  ds_read_b64_tr_b16 v[140:141], v25 offset:12288
  ds_read_b64_tr_b16 v[142:143], v25 offset:12800
  s_waitcnt lgkmcnt(7)
  ds_read_b64_tr_b16 v[144:145], v25 offset:16384
  ds_read_b64_tr_b16 v[146:147], v25 offset:16896
  ds_read_b64_tr_b16 v[148:149], v25 offset:20480
  ds_read_b64_tr_b16 v[150:151], v25 offset:20992
  ds_read_b64_tr_b16 v[152:153], v25 offset:24576
  ds_read_b64_tr_b16 v[154:155], v25 offset:25088
  ds_read_b64_tr_b16 v[156:157], v25 offset:28672
  ds_read_b64_tr_b16 v[158:159], v25 offset:29184
  s_waitcnt lgkmcnt(8)
  v_mfma_f32_16x16x32_bf16 v[224:227], v[96:99], v[128:131], 0
  v_mfma_f32_16x16x32_bf16 v[224:227], v[100:103], v[132:135], v[224:227]
  v_mfma_f32_16x16x32_bf16 v[224:227], v[104:107], v[136:139], v[224:227]
  v_mfma_f32_16x16x32_bf16 v[224:227], v[108:111], v[140:143], v[224:227]
  s_waitcnt lgkmcnt(7)
  ds_read_b64_tr_b16 v[128:129], v25 offset:32
  ds_read_b64_tr_b16 v[130:131], v25 offset:544
  ds_read_b64_tr_b16 v[132:133], v25 offset:4128
  ds_read_b64_tr_b16 v[134:135], v25 offset:4640
  ds_read_b64_tr_b16 v[136:137], v25 offset:8224
  ds_read_b64_tr_b16 v[138:139], v25 offset:8736
  ds_read_b64_tr_b16 v[140:141], v25 offset:12320
  ds_read_b64_tr_b16 v[142:143], v25 offset:12832
  s_waitcnt lgkmcnt(8)
  v_mfma_f32_16x16x32_bf16 v[224:227], v[112:115], v[144:147], v[224:227]
  v_mfma_f32_16x16x32_bf16 v[224:227], v[116:119], v[148:151], v[224:227]
  v_mfma_f32_16x16x32_bf16 v[224:227], v[120:123], v[152:155], v[224:227]
  v_mfma_f32_16x16x32_bf16 v[224:227], v[124:127], v[156:159], v[224:227]
  s_waitcnt lgkmcnt(7)
  ds_read_b64_tr_b16 v[144:145], v25 offset:16416
  ds_read_b64_tr_b16 v[146:147], v25 offset:16928
  ds_read_b64_tr_b16 v[148:149], v25 offset:20512
  ds_read_b64_tr_b16 v[150:151], v25 offset:21024
  ds_read_b64_tr_b16 v[152:153], v25 offset:24608
  ds_read_b64_tr_b16 v[154:155], v25 offset:25120
  ds_read_b64_tr_b16 v[156:157], v25 offset:28704
  ds_read_b64_tr_b16 v[158:159], v25 offset:29216
  s_waitcnt lgkmcnt(8)
  v_mfma_f32_16x16x32_bf16 v[228:231], v[96:99], v[128:131], 0
  v_mfma_f32_16x16x32_bf16 v[228:231], v[100:103], v[132:135], v[228:231]
  v_mfma_f32_16x16x32_bf16 v[228:231], v[104:107], v[136:139], v[228:231]
  v_mfma_f32_16x16x32_bf16 v[228:231], v[108:111], v[140:143], v[228:231]
  s_waitcnt lgkmcnt(0)
  v_mfma_f32_16x16x32_bf16 v[228:231], v[112:115], v[144:147], v[228:231]
  v_mfma_f32_16x16x32_bf16 v[228:231], v[116:119], v[148:151], v[228:231]
  v_mfma_f32_16x16x32_bf16 v[228:231], v[120:123], v[152:155], v[228:231]
  v_mfma_f32_16x16x32_bf16 v[228:231], v[124:127], v[156:159], v[228:231]
  v_mov_b32_dpp v226, v224 quad_perm:[1,0,3,2] row_mask:0xf bank_mask:0xf
  v_mov_b32 v225, s30
  v_mov_b32 v227, s30
  s_mov_b32 exec_lo, 0x55555555
  s_mov_b32 exec_hi, 0
  global_store_dwordx4 v26, v[224:227], s[28:29] offset:0 sc1
  s_mov_b64 exec, -1
  s_nop 0
  v_mov_b32_dpp v230, v228 quad_perm:[1,0,3,2] row_mask:0xf bank_mask:0xf
  v_mov_b32 v229, s30
  v_mov_b32 v231, s30
  s_mov_b32 exec_lo, 0x55555555
  s_mov_b32 exec_hi, 0
  global_store_dwordx4 v26, v[228:231], s[28:29] offset:128 sc1
  s_mov_b64 exec, -1
  s_sub_u32 s51, s51, 1
  s_cmp_eq_u32 s51, 0
  s_cbranch_scc1 L_pj_done
  v_add_u32 v25, 64, v25
  v_add_u32 v26, 256, v26
  s_branch L_pj_pair
L_pj_done:
  s_cmp_eq_u32 s44, 1
  s_cbranch_scc1 L_t1_h
  s_cmp_eq_u32 s66, 0
  s_cbranch_scc1 L_h0poll
  s_branch L_hwait
L_p23:
  s_waitcnt lgkmcnt(0)
  s_mul_i32 s30, s30, 0x9e3779b1
  s_add_u32 s30, s30, 0x85ebca6b
  s_branch L_h23
L_nonprod:
  s_waitcnt lgkmcnt(0)
  s_mul_i32 s30, s30, 0x9e3779b1
  s_add_u32 s30, s30, 0x85ebca6b
  s_cmp_eq_u32 s66, 0
  s_cbranch_scc0 L_h23
  s_sleep 58
L_h0poll:
  v_lshlrev_b32 v26, 10, v30
  v_lshl_add_u32 v26, v28, 8, v26
  v_lshl_add_u32 v26, v29, 6, v26
  s_lshl_b32 s46, s42, 15
  s_lshl_b32 s47, s43, 12
  s_add_u32 s46, s46, s47
  s_add_u32 s46, s46, 262144
  v_add_u32 v26, s46, v26
  v_add_u32 v16, 0x10000, v26
  s_sleep 40
  s_mov_b64 s[62:63], -1
L_q_poll:
  s_mov_b64 exec, s[62:63]
  global_load_dwordx4 v[96:99], v26, s[28:29] offset:0 sc1
  global_load_dwordx4 v[100:103], v26, s[28:29] offset:16 sc1
  global_load_dwordx4 v[104:107], v26, s[28:29] offset:32 sc1
  global_load_dwordx4 v[108:111], v26, s[28:29] offset:48 sc1
  global_load_dwordx4 v[112:115], v16, s[28:29] offset:0 sc1
  global_load_dwordx4 v[116:119], v16, s[28:29] offset:16 sc1
  global_load_dwordx4 v[120:123], v16, s[28:29] offset:32 sc1
  global_load_dwordx4 v[124:127], v16, s[28:29] offset:48 sc1
  s_waitcnt vmcnt(0)
  v_xor_b32 v224, s30, v97
  v_xor_b32 v225, s30, v99
  v_xor_b32 v226, s30, v101
  v_or3_b32 v224, v224, v225, v226
  v_xor_b32 v225, s30, v103
  v_xor_b32 v226, s30, v105
  v_or3_b32 v224, v224, v225, v226
  v_xor_b32 v225, s30, v107
  v_xor_b32 v226, s30, v109
  v_or3_b32 v224, v224, v225, v226
  v_xor_b32 v225, s30, v111
  v_xor_b32 v226, s30, v113
  v_or3_b32 v224, v224, v225, v226
  v_xor_b32 v225, s30, v115
  v_xor_b32 v226, s30, v117
  v_or3_b32 v224, v224, v225, v226
  v_xor_b32 v225, s30, v119
  v_xor_b32 v226, s30, v121
  v_or3_b32 v224, v224, v225, v226
  v_xor_b32 v225, s30, v123
  v_xor_b32 v226, s30, v125
  v_or3_b32 v224, v224, v225, v226
  v_xor_b32 v225, s30, v127
  v_or_b32 v224, v224, v225
  v_cmp_ne_u32 vcc, 0, v224
  s_nop 0
  s_mov_b64 s[62:63], vcc
  s_cbranch_vccz L_q_ok
  s_add_u32 s70, s70, 1
  s_cmp_gt_u32 s70, 2000000
  s_cbranch_scc1 L_end
  s_branch L_q_poll
L_q_ok:
  s_mov_b64 exec, -1
  v_add_f32 v64, v96, v112
  v_add_f32 v65, v98, v114
  v_add_f32 v66, v100, v116
  v_add_f32 v67, v102, v118
  v_add_f32 v68, v104, v120
  v_add_f32 v69, v106, v122
  v_add_f32 v70, v108, v124
  v_add_f32 v71, v110, v126
  v_cvt_pk_bf16_f32 v4, v64, v65
  v_cvt_pk_bf16_f32 v5, v66, v67
  v_cvt_pk_bf16_f32 v6, v68, v69
  v_cvt_pk_bf16_f32 v7, v70, v71
  ds_write_b128 v3, v[4:7] offset:3072
  v_mov_b32 v24, 1
  v_mov_b32 v25, 4352
  s_waitcnt lgkmcnt(0)
  ds_write_b32 v25, v24
  s_branch L_t1_h
L_h23:
  s_cmp_eq_u32 s66, 2
  s_cbranch_scc0 L_nodryloop
  s_mov_b32 s67, 1
  s_mov_b32 s71, 1
  s_mov_b32 s65, 0
  s_mov_b32 s4, 0
  s_mov_b32 s5, 0
  s_branch L_bodyB
L_dryloop_ret:
  s_mov_b32 s67, 0
  v_lshrrev_b32 v20, 3, v1
  v_and_b32 v21, 7, v1
  v_lshlrev_b32 v21, 4, v21
L_nodryloop:
L_hwait:
  v_mov_b32 v24, 4352
L_hq_spin:
  ds_read_b32 v25, v24
  s_waitcnt lgkmcnt(0)
  v_cmp_ne_u32 vcc, 1, v25
  s_cbranch_vccz L_hq_ok
  s_add_u32 s70, s70, 1
  s_cmp_gt_u32 s70, 2000000
  s_cbranch_scc1 L_end
  s_sleep 4
  s_branch L_hq_spin
L_hq_ok:
  s_cmp_eq_u32 s66, 1
  s_cbranch_scc1 L_h1
  s_cmp_eq_u32 s66, 3
  s_cbranch_scc1 L_h3
  v_lshl_add_u32 v22, v20, 10, v21
  s_lshl_b32 s46, s57, 17
  s_lshl_b32 s47, s58, 7
  s_add_u32 s46, s46, s47
  s_add_u32 s48, s16, s46
  s_addc_u32 s49, s17, 0
  s_mov_b32 m0, 37888
  s_nop 0
  global_load_lds_dwordx4 v22, s[48:49] offset:0 nt
  v_add_u32 v22, 7168, v22
  global_load_lds_dwordx4 v22, s[48:49] offset:1024 nt
  v_add_u32 v22, 7168, v22
  global_load_lds_dwordx4 v22, s[48:49] offset:2048 nt
  v_add_u32 v22, 7168, v22
  global_load_lds_dwordx4 v22, s[48:49] offset:3072 nt
  v_add_u32 v22, 7168, v22
  s_mov_b32 m0, 41984
  v_add_u32 v22, 4096, v22
  global_load_lds_dwordx4 v22, s[48:49] offset:0 nt
  v_add_u32 v22, 7168, v22
  global_load_lds_dwordx4 v22, s[48:49] offset:1024 nt
  v_add_u32 v22, 7168, v22
  global_load_lds_dwordx4 v22, s[48:49] offset:2048 nt
  v_add_u32 v22, 7168, v22
  global_load_lds_dwordx4 v22, s[48:49] offset:3072 nt
  v_add_u32 v22, 7168, v22
  s_mov_b32 m0, 46080
  v_add_u32 v22, 4096, v22
  global_load_lds_dwordx4 v22, s[48:49] offset:0 nt
  v_add_u32 v22, 7168, v22
  global_load_lds_dwordx4 v22, s[48:49] offset:1024 nt
  v_add_u32 v22, 7168, v22
  global_load_lds_dwordx4 v22, s[48:49] offset:2048 nt
  v_add_u32 v22, 7168, v22
  global_load_lds_dwordx4 v22, s[48:49] offset:3072 nt
  v_add_u32 v22, 7168, v22
  s_mov_b32 m0, 50176
  v_add_u32 v22, 4096, v22
  global_load_lds_dwordx4 v22, s[48:49] offset:0 nt
  v_add_u32 v22, 7168, v22
  global_load_lds_dwordx4 v22, s[48:49] offset:1024 nt
  v_add_u32 v22, 7168, v22
  global_load_lds_dwordx4 v22, s[48:49] offset:2048 nt
  v_add_u32 v22, 7168, v22
  global_load_lds_dwordx4 v22, s[48:49] offset:3072 nt
  s_mov_b64 exec, 0
  s_branch L_chain_t_0
L_chain_ret:
  s_mov_b64 exec, -1
  s_branch L_t1_h
L_h1:
  s_bitcmp1_b32 s2, 2
  s_cbranch_scc0 L_t1_h
  s_mov_b32 s50, s3
  s_cmp_ge_u32 s50, 56
  s_cbranch_scc1 L_t1_h
  global_load_dwordx4 v[224:227], v3, s[8:9]
  global_load_dwordx4 v[228:231], v3, s[8:9] offset:1024
  global_load_dwordx2 v[232:233], v23, s[8:9]
  global_load_dwordx2 v[234:235], v23, s[8:9] offset:1024
  s_movk_i32 s51, 3584
  v_mad_u32_u24 v22, v20, s51, v21
  s_mul_i32 s46, s45, 917504
  s_lshr_b32 s47, s50, 1
  s_lshl_b32 s47, s47, 7
  s_add_u32 s46, s46, s47
  s_add_u32 s48, s20, s46
  s_addc_u32 s49, s21, 0
  s_mov_b32 m0, 5120
  s_nop 0
  global_load_lds_dwordx4 v22, s[48:49] offset:0 nt
  v_add_u32 v22, 27648, v22
  global_load_lds_dwordx4 v22, s[48:49] offset:1024 nt
  v_add_u32 v22, 27648, v22
  global_load_lds_dwordx4 v22, s[48:49] offset:2048 nt
  v_add_u32 v22, 27648, v22
  global_load_lds_dwordx4 v22, s[48:49] offset:3072 nt
  v_add_u32 v22, 27648, v22
  s_mov_b32 m0, 9216
  v_add_u32 v22, 4096, v22
  global_load_lds_dwordx4 v22, s[48:49] offset:0 nt
  v_add_u32 v22, 27648, v22
  global_load_lds_dwordx4 v22, s[48:49] offset:1024 nt
  v_add_u32 v22, 27648, v22
  global_load_lds_dwordx4 v22, s[48:49] offset:2048 nt
  v_add_u32 v22, 27648, v22
  global_load_lds_dwordx4 v22, s[48:49] offset:3072 nt
  v_add_u32 v22, 27648, v22
  s_mov_b32 m0, 13312
  v_add_u32 v22, 4096, v22
  global_load_lds_dwordx4 v22, s[48:49] offset:0 nt
  v_add_u32 v22, 27648, v22
  global_load_lds_dwordx4 v22, s[48:49] offset:1024 nt
  v_add_u32 v22, 27648, v22
  global_load_lds_dwordx4 v22, s[48:49] offset:2048 nt
  v_add_u32 v22, 27648, v22
  global_load_lds_dwordx4 v22, s[48:49] offset:3072 nt
  v_add_u32 v22, 27648, v22
  s_mov_b32 m0, 17408
  v_add_u32 v22, 4096, v22
  global_load_lds_dwordx4 v22, s[48:49] offset:0 nt
  v_add_u32 v22, 27648, v22
  global_load_lds_dwordx4 v22, s[48:49] offset:1024 nt
  v_add_u32 v22, 27648, v22
  global_load_lds_dwordx4 v22, s[48:49] offset:2048 nt
  v_add_u32 v22, 27648, v22
  global_load_lds_dwordx4 v22, s[48:49] offset:3072 nt
  v_add_u32 v22, 27648, v22
  s_mov_b32 m0, 21504
  v_add_u32 v22, 4096, v22
  global_load_lds_dwordx4 v22, s[48:49] offset:0 nt
  v_add_u32 v22, 27648, v22
  global_load_lds_dwordx4 v22, s[48:49] offset:1024 nt
  v_add_u32 v22, 27648, v22
  global_load_lds_dwordx4 v22, s[48:49] offset:2048 nt
  v_add_u32 v22, 27648, v22
  global_load_lds_dwordx4 v22, s[48:49] offset:3072 nt
  v_add_u32 v22, 27648, v22
  s_mov_b32 m0, 25600
  v_add_u32 v22, 4096, v22
  global_load_lds_dwordx4 v22, s[48:49] offset:0 nt
  v_add_u32 v22, 27648, v22
  global_load_lds_dwordx4 v22, s[48:49] offset:1024 nt
  v_add_u32 v22, 27648, v22
  global_load_lds_dwordx4 v22, s[48:49] offset:2048 nt
  v_add_u32 v22, 27648, v22
  global_load_lds_dwordx4 v22, s[48:49] offset:3072 nt
  v_add_u32 v22, 27648, v22
  s_mov_b32 m0, 29696
  v_add_u32 v22, 4096, v22
  global_load_lds_dwordx4 v22, s[48:49] offset:0 nt
  v_add_u32 v22, 27648, v22
  global_load_lds_dwordx4 v22, s[48:49] offset:1024 nt
  v_add_u32 v22, 27648, v22
  global_load_lds_dwordx4 v22, s[48:49] offset:2048 nt
  v_add_u32 v22, 27648, v22
  global_load_lds_dwordx4 v22, s[48:49] offset:3072 nt
  v_add_u32 v22, 27648, v22
  s_mov_b32 m0, 33792
  v_add_u32 v22, 4096, v22
  global_load_lds_dwordx4 v22, s[48:49] offset:0 nt
  v_add_u32 v22, 27648, v22
  global_load_lds_dwordx4 v22, s[48:49] offset:1024 nt
  v_add_u32 v22, 27648, v22
  global_load_lds_dwordx4 v22, s[48:49] offset:2048 nt
  v_add_u32 v22, 27648, v22
  global_load_lds_dwordx4 v22, s[48:49] offset:3072 nt
  s_mov_b32 s44, 1
  s_movk_i32 s46, 1024
  s_mov_b32 s47, 5120
  s_lshl_b32 s48, s45, 15
  s_lshr_b32 s50, s50, 1
  s_lshl_b32 s50, s50, 9
  s_add_u32 s48, s48, s50
  s_add_u32 s48, s48, 524288
  s_movk_i32 s49, 16384
  s_mov_b32 s51, 2
  s_waitcnt vmcnt(32)
  s_branch L_proj
L_h3:
  s_bitcmp1_b32 s2, 2
  s_cbranch_scc0 L_h3b
  s_sub_u32 s59, s3, 16
  s_cmp_ge_u32 s59, 112
  s_cbranch_scc1 L_h3b
  v_lshl_add_u32 v22, v20, 10, v21
  s_lshr_b32 s46, s59, 3
  s_lshl_b32 s46, s46, 17
  s_and_b32 s47, s59, 7
  s_lshl_b32 s47, s47, 7
  s_add_u32 s46, s46, s47
  s_add_u32 s48, s22, s46
  s_addc_u32 s49, s23, 0
  s_mov_b32 m0, 54272
  s_nop 0
  global_load_lds_dwordx4 v22, s[48:49] offset:0 nt
  v_add_u32 v22, 7168, v22
  global_load_lds_dwordx4 v22, s[48:49] offset:1024 nt
  v_add_u32 v22, 7168, v22
  global_load_lds_dwordx4 v22, s[48:49] offset:2048 nt
  v_add_u32 v22, 7168, v22
  global_load_lds_dwordx4 v22, s[48:49] offset:3072 nt
  v_add_u32 v22, 7168, v22
  s_mov_b32 m0, 58368
  v_add_u32 v22, 4096, v22
  global_load_lds_dwordx4 v22, s[48:49] offset:0 nt
  v_add_u32 v22, 7168, v22
  global_load_lds_dwordx4 v22, s[48:49] offset:1024 nt
  v_add_u32 v22, 7168, v22
  global_load_lds_dwordx4 v22, s[48:49] offset:2048 nt
  v_add_u32 v22, 7168, v22
  global_load_lds_dwordx4 v22, s[48:49] offset:3072 nt
  v_add_u32 v22, 7168, v22
  s_mov_b32 m0, 62464
  v_add_u32 v22, 4096, v22
  global_load_lds_dwordx4 v22, s[48:49] offset:0 nt
  v_add_u32 v22, 7168, v22
  global_load_lds_dwordx4 v22, s[48:49] offset:1024 nt
  v_add_u32 v22, 7168, v22
  global_load_lds_dwordx4 v22, s[48:49] offset:2048 nt
  v_add_u32 v22, 7168, v22
  global_load_lds_dwordx4 v22, s[48:49] offset:3072 nt
  v_add_u32 v22, 7168, v22
  s_mov_b32 m0, 66560
  v_add_u32 v22, 4096, v22
  global_load_lds_dwordx4 v22, s[48:49] offset:0 nt
  v_add_u32 v22, 7168, v22
  global_load_lds_dwordx4 v22, s[48:49] offset:1024 nt
  v_add_u32 v22, 7168, v22
  global_load_lds_dwordx4 v22, s[48:49] offset:2048 nt
  v_add_u32 v22, 7168, v22
  global_load_lds_dwordx4 v22, s[48:49] offset:3072 nt
  v_lshrrev_b32 v26, 5, v1
  v_lshlrev_b32 v26, 14, v26
  v_and_b32 v27, 31, v1
  v_lshl_add_u32 v26, v27, 5, v26
  s_lshr_b32 s46, s59, 3
  s_lshl_b32 s46, s46, 10
  s_add_u32 s46, s46, 524288
  v_add_u32 v26, s46, v26
  v_add_u32 v16, 0x8000, v26
L_hpoll:
  global_load_dwordx4 v[96:99], v26, s[28:29] offset:0 sc1
  global_load_dwordx4 v[100:103], v26, s[28:29] offset:16 sc1
  global_load_dwordx4 v[104:107], v16, s[28:29] offset:0 sc1
  global_load_dwordx4 v[108:111], v16, s[28:29] offset:16 sc1
  s_waitcnt vmcnt(0)
  v_xor_b32 v224, s30, v97
  v_xor_b32 v225, s30, v99
  v_xor_b32 v226, s30, v101
  v_or3_b32 v224, v224, v225, v226
  v_xor_b32 v225, s30, v103
  v_xor_b32 v226, s30, v105
  v_or3_b32 v224, v224, v225, v226
  v_xor_b32 v225, s30, v107
  v_xor_b32 v226, s30, v109
  v_or3_b32 v224, v224, v225, v226
  v_xor_b32 v225, s30, v111
  v_or_b32 v224, v224, v225
  v_cmp_ne_u32 vcc, 0, v224
  s_cbranch_vccz L_hok
  s_add_u32 s70, s70, 1
  s_cmp_gt_u32 s70, 2000000
  s_cbranch_scc1 L_end
  s_sleep 8
  s_branch L_hpoll
L_hok:
  v_add_f32 v64, v96, v104
  v_add_f32 v65, v98, v106
  v_add_f32 v66, v100, v108
  v_add_f32 v67, v102, v110
  v_cvt_pk_bf16_f32 v72, v64, v65
  v_lshlrev_b32 v64, 16, v72
  v_and_b32 v65, s56, v72
  v_cvt_pk_bf16_f32 v72, v66, v67
  v_lshlrev_b32 v66, 16, v72
  v_and_b32 v67, s56, v72
  v_mul_f32 v72, s53, v64
  v_exp_f32 v72, -v72
  s_nop 0
  v_add_f32 v72, 1.0, v72
  v_rcp_f32 v73, v72
  s_nop 0
  v_mul_f32 v74, v64, v73
  v_fma_f32 v72, -v74, v72, v64
  v_fma_f32 v64, v72, v73, v74
  v_cvt_pk_bf16_f32 v72, v64, v64
  v_lshlrev_b32 v64, 16, v72
  v_mul_f32 v72, s53, v65
  v_exp_f32 v72, -v72
  s_nop 0
  v_add_f32 v72, 1.0, v72
  v_rcp_f32 v73, v72
  s_nop 0
  v_mul_f32 v74, v65, v73
  v_fma_f32 v72, -v74, v72, v65
  v_fma_f32 v65, v72, v73, v74
  v_cvt_pk_bf16_f32 v72, v65, v65
  v_lshlrev_b32 v65, 16, v72
  v_mul_f32 v72, s53, v66
  v_exp_f32 v72, -v72
  s_nop 0
  v_add_f32 v72, 1.0, v72
  v_rcp_f32 v73, v72
  s_nop 0
  v_mul_f32 v74, v66, v73
  v_fma_f32 v72, -v74, v72, v66
  v_fma_f32 v66, v72, v73, v74
  v_cvt_pk_bf16_f32 v72, v66, v66
  v_lshlrev_b32 v66, 16, v72
  v_mul_f32 v72, s53, v67
  v_exp_f32 v72, -v72
  s_nop 0
  v_add_f32 v72, 1.0, v72
  v_rcp_f32 v73, v72
  s_nop 0
  v_mul_f32 v74, v67, v73
  v_fma_f32 v72, -v74, v72, v67
  v_fma_f32 v67, v72, v73, v74
  v_cvt_pk_bf16_f32 v72, v67, v67
  v_lshlrev_b32 v67, 16, v72
  v_cvt_pk_bf16_f32 v68, v64, v65
  v_cvt_pk_bf16_f32 v69, v66, v67
  v_lshlrev_b32 v24, 3, v1
  ds_write_b64 v24, v[68:69] offset:2048
  v_bfe_u32 v24, v1, 2, 1
  v_lshlrev_b32 v24, 8, v24
  v_lshl_add_u32 v24, v28, 4, v24
  v_add_u32 v24, 2048, v24
  v_lshlrev_b32 v25, 10, v28
  v_lshl_add_u32 v25, v29, 7, v25
  v_lshl_add_u32 v25, v30, 3, v25
  v_add_u32 v25, 54272, v25
  s_waitcnt lgkmcnt(0)
  ds_read_b128 v[96:99], v24 offset:0
  ds_read_b128 v[100:103], v24 offset:64
  ds_read_b128 v[104:107], v24 offset:128
  ds_read_b128 v[108:111], v24 offset:192
  ds_read_b64_tr_b16 v[112:113], v25 offset:0
  ds_read_b64_tr_b16 v[114:115], v25 offset:512
  ds_read_b64_tr_b16 v[116:117], v25 offset:4096
  ds_read_b64_tr_b16 v[118:119], v25 offset:4608
  ds_read_b64_tr_b16 v[120:121], v25 offset:8192
  ds_read_b64_tr_b16 v[122:123], v25 offset:8704
  ds_read_b64_tr_b16 v[124:125], v25 offset:12288
  ds_read_b64_tr_b16 v[126:127], v25 offset:12800
  s_waitcnt lgkmcnt(7)
  ds_read_b64_tr_b16 v[128:129], v25 offset:32
  ds_read_b64_tr_b16 v[130:131], v25 offset:544
  ds_read_b64_tr_b16 v[132:133], v25 offset:4128
  ds_read_b64_tr_b16 v[134:135], v25 offset:4640
  ds_read_b64_tr_b16 v[136:137], v25 offset:8224
  ds_read_b64_tr_b16 v[138:139], v25 offset:8736
  ds_read_b64_tr_b16 v[140:141], v25 offset:12320
  ds_read_b64_tr_b16 v[142:143], v25 offset:12832
  s_waitcnt lgkmcnt(8)
  v_mfma_f32_16x16x32_bf16 v[224:227], v[96:99], v[112:115], 0
  v_mfma_f32_16x16x32_bf16 v[224:227], v[100:103], v[116:119], v[224:227]
  v_mfma_f32_16x16x32_bf16 v[224:227], v[104:107], v[120:123], v[224:227]
  v_mfma_f32_16x16x32_bf16 v[224:227], v[108:111], v[124:127], v[224:227]
  s_waitcnt lgkmcnt(7)
  ds_read_b64_tr_b16 v[112:113], v25 offset:64
  ds_read_b64_tr_b16 v[114:115], v25 offset:576
  ds_read_b64_tr_b16 v[116:117], v25 offset:4160
  ds_read_b64_tr_b16 v[118:119], v25 offset:4672
  ds_read_b64_tr_b16 v[120:121], v25 offset:8256
  ds_read_b64_tr_b16 v[122:123], v25 offset:8768
  ds_read_b64_tr_b16 v[124:125], v25 offset:12352
  ds_read_b64_tr_b16 v[126:127], v25 offset:12864
  s_waitcnt lgkmcnt(8)
  v_mfma_f32_16x16x32_bf16 v[228:231], v[96:99], v[128:131], 0
  v_mfma_f32_16x16x32_bf16 v[228:231], v[100:103], v[132:135], v[228:231]
  v_mfma_f32_16x16x32_bf16 v[228:231], v[104:107], v[136:139], v[228:231]
  v_mfma_f32_16x16x32_bf16 v[228:231], v[108:111], v[140:143], v[228:231]
  s_waitcnt lgkmcnt(7)
  ds_read_b64_tr_b16 v[128:129], v25 offset:96
  ds_read_b64_tr_b16 v[130:131], v25 offset:608
  ds_read_b64_tr_b16 v[132:133], v25 offset:4192
  ds_read_b64_tr_b16 v[134:135], v25 offset:4704
  ds_read_b64_tr_b16 v[136:137], v25 offset:8288
  ds_read_b64_tr_b16 v[138:139], v25 offset:8800
  ds_read_b64_tr_b16 v[140:141], v25 offset:12384
  ds_read_b64_tr_b16 v[142:143], v25 offset:12896
  s_waitcnt lgkmcnt(8)
  v_mfma_f32_16x16x32_bf16 v[232:235], v[96:99], v[112:115], 0
  v_mfma_f32_16x16x32_bf16 v[232:235], v[100:103], v[116:119], v[232:235]
  v_mfma_f32_16x16x32_bf16 v[232:235], v[104:107], v[120:123], v[232:235]
  v_mfma_f32_16x16x32_bf16 v[232:235], v[108:111], v[124:127], v[232:235]
  s_waitcnt lgkmcnt(0)
  v_mfma_f32_16x16x32_bf16 v[236:239], v[96:99], v[128:131], 0
  v_mfma_f32_16x16x32_bf16 v[236:239], v[100:103], v[132:135], v[236:239]
  v_mfma_f32_16x16x32_bf16 v[236:239], v[104:107], v[136:139], v[236:239]
  v_mfma_f32_16x16x32_bf16 v[236:239], v[108:111], v[140:143], v[236:239]
  s_and_b32 s46, s59, 7
  s_lshl_b32 s46, s46, 14
  s_lshr_b32 s47, s59, 3
  s_lshl_b32 s47, s47, 7
  s_add_u32 s46, s46, s47
  s_add_u32 s46, s46, 2621440
  v_bfe_u32 v26, v1, 3, 1
  v_lshlrev_b32 v26, 11, v26
  v_bfe_u32 v27, v1, 4, 1
  v_lshl_add_u32 v26, v27, 6, v26
  v_and_b32 v27, 7, v1
  v_lshl_add_u32 v26, v27, 3, v26
  v_add_u32 v26, s46, v26
  v_mov_b32_dpp v226, v224 quad_perm:[1,0,3,2] row_mask:0xf bank_mask:0xf
  v_mov_b32 v225, s30
  v_mov_b32 v227, s30
  s_mov_b32 exec_lo, 0x55555555
  s_mov_b32 exec_hi, 0
  global_store_dwordx4 v26, v[224:227], s[28:29] offset:0 sc1
  s_mov_b64 exec, -1
  v_add_u32 v26, 4096, v26
  v_mov_b32_dpp v230, v228 quad_perm:[1,0,3,2] row_mask:0xf bank_mask:0xf
  v_mov_b32 v229, s30
  v_mov_b32 v231, s30
  s_mov_b32 exec_lo, 0x55555555
  s_mov_b32 exec_hi, 0
  global_store_dwordx4 v26, v[228:231], s[28:29] offset:0 sc1
  s_mov_b64 exec, -1
  v_add_u32 v26, 4096, v26
  v_mov_b32_dpp v234, v232 quad_perm:[1,0,3,2] row_mask:0xf bank_mask:0xf
  v_mov_b32 v233, s30
  v_mov_b32 v235, s30
  s_mov_b32 exec_lo, 0x55555555
  s_mov_b32 exec_hi, 0
  global_store_dwordx4 v26, v[232:235], s[28:29] offset:0 sc1
  s_mov_b64 exec, -1
  v_add_u32 v26, 4096, v26
  v_mov_b32_dpp v238, v236 quad_perm:[1,0,3,2] row_mask:0xf bank_mask:0xf
  v_mov_b32 v237, s30
  v_mov_b32 v239, s30
  s_mov_b32 exec_lo, 0x55555555
  s_mov_b32 exec_hi, 0
  global_store_dwordx4 v26, v[236:239], s[28:29] offset:0 sc1
  s_mov_b64 exec, -1
L_h3b:
  s_cmp_ge_u32 s2, 64
  s_cbranch_scc1 L_t4pre_done
  s_lshl_b32 s46, s2, 11
  s_add_u32 s46, s46, 2621440
  v_add_u32 v25, s46, v3
  v_bfe_u32 v26, v1, 2, 1
  v_lshlrev_b32 v26, 10, v26
  v_and_b32 v27, 3, v1
  v_lshl_add_u32 v26, v27, 2, v26
  s_lshl_b32 s46, s2, 4
  v_add_u32 v206, s46, v26
  global_load_dword v12, v206, s[8:9]
  v_mov_b32 v84, 0
  v_mov_b32 v85, 0
  v_mov_b32 v86, 0
  v_mov_b32 v87, 0
  v_mov_b32 v85, s30
  v_mov_b32 v87, s30
L_fgpoll:
  global_load_dwordx4 v[80:83], v25, s[28:29] sc1
  s_mov_b32 exec_hi, 0xffff
  global_load_dwordx4 v[84:87], v25, s[28:29] offset:1024 sc1
  s_mov_b64 exec, -1
  s_waitcnt vmcnt(0)
  v_xor_b32 v16, s30, v81
  v_xor_b32 v17, s30, v83
  v_xor_b32 v18, s30, v85
  v_or3_b32 v16, v16, v17, v18
  v_xor_b32 v17, s30, v87
  v_or_b32 v16, v16, v17
  v_cmp_ne_u32 vcc, 0, v16
  s_cbranch_vccz L_fgok
  s_add_u32 s70, s70, 1
  s_cmp_gt_u32 s70, 2000000
  s_cbranch_scc1 L_end
  s_sleep 32
  s_branch L_fgpoll
L_fgok:
  v_add_f32 v18, v80, v84
  v_add_f32 v19, v82, v86
  s_nop 0
  v_add_f32_dpp v18, v18, v18 row_ror:8 row_mask:0xf bank_mask:0xf
  v_add_f32_dpp v19, v19, v19 row_ror:8 row_mask:0xf bank_mask:0xf
  v_mov_b32 v14, v18
  v_mov_b32 v15, v19
  s_nop 0
  v_permlane32_swap_b32 v18, v14
  v_permlane32_swap_b32 v19, v15
  v_add_f32 v18, v18, v14
  v_add_f32 v19, v19, v15
  v_mov_b32 v14, v18
  v_mov_b32 v15, v19
  s_nop 0
  v_permlane16_swap_b32 v18, v14
  v_permlane16_swap_b32 v19, v15
  v_add_f32 v18, v18, v14
  v_add_f32 v19, v19, v15
  v_cvt_pk_bf16_f32 v20, v18, v19
  v_lshlrev_b32 v18, 16, v20
  v_and_b32 v19, s56, v20
  v_mul_f32 v20, s53, v18
  v_exp_f32 v20, -v20
  s_nop 0
  v_add_f32 v20, 1.0, v20
  v_rcp_f32 v21, v20
  s_nop 0
  v_mul_f32 v22, v18, v21
  v_fma_f32 v20, -v22, v20, v18
  v_fma_f32 v18, v20, v21, v22
  v_cvt_pk_bf16_f32 v20, v18, v18
  v_lshlrev_b32 v18, 16, v20
  v_mul_f32 v20, s53, v19
  v_exp_f32 v20, -v20
  s_nop 0
  v_add_f32 v20, 1.0, v20
  v_rcp_f32 v21, v20
  s_nop 0
  v_mul_f32 v22, v19, v21
  v_fma_f32 v20, -v22, v20, v19
  v_fma_f32 v19, v20, v21, v22
  v_cvt_pk_bf16_f32 v20, v19, v19
  v_lshlrev_b32 v19, 16, v20
  v_mov_b32 v200, v18
  v_mov_b32 v201, v19
  v_lshlrev_b32 v202, 16, v12
  v_and_b32 v203, s56, v12
L_t4pre_done:
  s_branch L_t1_h
L_code_end:
.section .rodata,"a"
.p2align 6
.amdhsa_kernel recurrent_scan__gqa_block_cached__dense_activation_silu__decode_kernel
  .amdhsa_next_free_vgpr 256
  .amdhsa_next_free_sgpr 100
  .amdhsa_accum_offset 256
  .amdhsa_group_segment_fixed_size 0
  .amdhsa_kernarg_size 88
  .amdhsa_user_sgpr_count 2
  .amdhsa_user_sgpr_kernarg_segment_ptr 1
  .amdhsa_system_sgpr_workgroup_id_x 1
  .amdhsa_float_denorm_mode_32 3
.end_amdhsa_kernel
```
